```python
import torch

def _softmax(x, axis=-1):
    return torch.softmax(x, dim=axis)
def _gelu(x):
    return torch.nn.functional.gelu(x, approximate="tanh")
def _silu(x):
    return torch.nn.functional.silu(x)
def _sigmoid(x):
    return torch.sigmoid(x)
def _layernorm(x, axis=-1, eps=1e-5):
    m = x.mean(dim=axis, keepdim=True)
    v = x.var(dim=axis, keepdim=True, unbiased=False)
    return (x - m) / torch.sqrt(v + eps)
def _scatter_add(tgt, idx, src, axis=0):
    return tgt.clone().index_add_(axis, idx, src)
def _segment_sum(src, seg, n):
    out = torch.zeros((n,) + src.shape[1:], dtype=src.dtype)
    return out.index_add_(0, seg, src)
def _pad(x, pw):
    flat = tuple(v for pair in reversed(pw) for v in pair)
    return torch.nn.functional.pad(x, flat)

kernel_name = 'concat_heads__ssm_conv_s4d__ssm_conv_h3__prompt'

def setup_inputs():

    _w = (lambda a: (lambda t: t.to(torch.bfloat16) if t.is_floating_point() else t)(torch.as_tensor(a)))
    def _A_setup():
        Bsz, L, D, N = 1, 2048, 1024, 128
        return {
            "u": _w((lambda *s: torch.randn(*s, dtype=torch.bfloat16) * 0.05)(Bsz, L, D)),
            "log_A_real": _w((lambda *s: torch.randn(*s, dtype=torch.bfloat16) * 3.2)(D, N) * 0.5),
            "A_imag": _w((lambda *s: torch.randn(*s, dtype=torch.bfloat16) * 0.05)(D, N) * 3.14),
            "C_real": _w((lambda *s: torch.randn(*s, dtype=torch.bfloat16) * 0.1)(D, N) / N ** 0.5),
            "C_imag": _w((lambda *s: torch.randn(*s, dtype=torch.bfloat16) * 0.1)(D, N) / N ** 0.5),
            "log_dt": _w((lambda *s: torch.randn(*s, dtype=torch.bfloat16) * 0.05)(D) * 0.5 - 4.0),
            "D_skip": _w((lambda *s: torch.randn(*s, dtype=torch.bfloat16) * 0.05)(D)),
        }
    _A_in = _A_setup()

    def _B_setup():
        B, S, D = 1, 2048, 1024
        ks = 4
        return {
            "q": _w((lambda *s: torch.randn(*s, dtype=torch.bfloat16) * 0.05)(B, S, D)),
            "k": _w((lambda *s: torch.randn(*s, dtype=torch.bfloat16) * 0.2)(B, S, D)),
            "v": _w((lambda *s: torch.randn(*s, dtype=torch.bfloat16) * 0.2)(B, S, D)),
            "shift_k": _w((lambda *s: torch.randn(*s, dtype=torch.bfloat16) * 0.2)(D, ks) * 0.5),
            "ssm_k": _w((lambda *s: torch.randn(*s, dtype=torch.bfloat16) * 0.8)(D, S) * (1.0 / S ** 0.5)),
            "ssm_D": _w((lambda *s: torch.randn(*s, dtype=torch.bfloat16) * 0.2)(D)),
        }
    _B_in = _B_setup()

    return {
        "A_u": _A_in["u"],
        "A_log_A_real": _A_in["log_A_real"],
        "A_A_imag": _A_in["A_imag"],
        "A_C_real": _A_in["C_real"],
        "A_C_imag": _A_in["C_imag"],
        "A_log_dt": _A_in["log_dt"],
        "A_D_skip": _A_in["D_skip"],
        "B_q": _B_in["q"],
        "B_k": _B_in["k"],
        "B_v": _B_in["v"],
        "B_shift_k": _B_in["shift_k"],
        "B_ssm_k": _B_in["ssm_k"],
        "B_ssm_D": _B_in["ssm_D"],
    }

def reference(A_u, A_log_A_real, A_A_imag, A_C_real, A_C_imag, A_log_dt, A_D_skip, B_q, B_k, B_v, B_shift_k, B_ssm_k, B_ssm_D):
    def _A_ref(u, log_A_real, A_imag, C_real, C_imag, log_dt, D_skip):
        L = u.shape[1]
        dt = torch.exp(log_dt)
        A = -torch.exp(log_A_real) + 1j * A_imag
        C = (C_real + 1j * C_imag) * dt[:, None]
        pos = (lambda x, dt: x.to(dt))(torch.arange(L), log_dt.dtype)
        P = torch.exp((A * dt[:, None])[:, :, None] * pos[None, None, :])
        K = 2.0 * torch.einsum("dn,dnl->dl", C, P).real
        L2 = 2 * L
        u_t = (lambda x, *d: x.permute(*d))(u, 0, 2, 1)
        Kf = (lambda x, *a, **k: torch.fft.rfft(x.float(), *a, **k))(K, L2)
        Uf = (lambda x, *a, **k: torch.fft.rfft(x.float(), *a, **k))(u_t, L2)
        y = (lambda x, *a, **k: torch.fft.irfft(x, *a, **k).to(torch.bfloat16))(Uf * Kf[None, :, :], L2)[:, :, :L]
        y = (lambda x, *d: x.permute(*d))(y, 0, 2, 1)
        return y + u * D_skip[None, None, :]

    def _B_ref(q, k, v, shift_k, ssm_k, ssm_D):
        B, S, D = q.shape
        ks = shift_k.shape[-1]
        k_pad = _pad(k, ((0, 0), (ks - 1, 0), (0, 0)))
        k_shift = torch.zeros_like(k)
        for t in range(ks):
            k_shift = k_shift + k_pad[:, t:t + S, :] * shift_k[:, ks - 1 - t][None, None, :]
        kv = k_shift * v
        L = 2 * S
        kv_pad = _pad(kv, ((0, 0), (0, S), (0, 0)))
        kf_pad = _pad(ssm_k, ((0, 0), (0, S)))
        kv_f = (lambda x, axes=(-2,-1): torch.fft.rfft2(x.float(), dim=axes))(kv_pad[:, None, :, :], axes=(1, 2))
        kf_f = (lambda x, axes=(-2,-1): torch.fft.rfft2(x.float(), dim=axes))(kf_pad[:, None, :], axes=(1, 2))
        kf_f = (lambda x, *d: x.permute(*d))(kf_f, 1, 2, 0)
        y_f = kv_f * kf_f[None, :, :, :]
        y = (lambda x, s, axes=(-2,-1): torch.fft.irfft2(x, s=s, dim=axes).to(torch.bfloat16))(y_f, (1, L), axes=(1, 2))[:, 0, :S, :]
        y = y + kv * ssm_D[None, None, :]
        return q * y

    a = _A_ref(A_u, A_log_A_real, A_A_imag, A_C_real, A_C_imag, A_log_dt, A_D_skip)
    b = _B_ref(B_q, B_k, B_v, B_shift_k, B_ssm_k, B_ssm_D)
    return torch.concatenate([a, b], axis=-1)
```

```asm
; @launch grid=(256,1,1) block=(512,1,1) lds=163840
.amdgcn_target "amdgcn-amd-amdhsa--gfx950"
.text
.p2align 8
.globl concat_heads__ssm_conv_s4d__ssm_conv_h3__prompt_kernel
.type concat_heads__ssm_conv_s4d__ssm_conv_h3__prompt_kernel,@function
concat_heads__ssm_conv_s4d__ssm_conv_h3__prompt_kernel:
    s_cmp_ge_u32 s2, 256
    s_cbranch_scc1 L_end
    s_load_dwordx8 s[44:51], s[0:1], 8
    s_load_dwordx4 s[64:67], s[0:1], 40
    s_load_dwordx8 s[68:75], s[0:1], 56
    s_load_dwordx2 s[98:99], s[0:1], 0
    s_load_dwordx4 s[76:79], s[0:1], 88
    s_load_dwordx4 s[80:83], s[0:1], 104
    s_load_dwordx2 s[54:55], s[0:1], 120
    s_and_b32 s3, s2, 7
    s_lshl_b32 s3, s3, 5
    s_lshr_b32 s4, s2, 3
    s_add_u32 s3, s3, s4
    v_lshrrev_b32 v1, 6, v0
    s_nop 0
    v_readfirstlane_b32 s4, v1
    v_and_b32 v1, 63, v0
    s_lshl_b32 s5, s3, 3
    s_and_b32 s7, s4, 3
    s_lshr_b32 s6, s4, 2
    s_mul_i32 s38, s7, 40960
    s_mul_i32 s39, s6, 24224
    s_add_u32 s38, s38, s39
    s_lshl_b32 s36, s3, 2
    s_add_u32 s7, s7, s36
    v_mov_b32 v120, 20832
    v_mov_b32 v122, 0
    v_mov_b32 v123, 0
    v_cmp_eq_u32 vcc, 0, v0
    s_nop 0
    s_and_saveexec_b64 s[42:43], vcc
    ds_write_b64 v120, v[122:123]
    ds_write_b64 v120, v[122:123] offset:8
    ds_write_b64 v120, v[122:123] offset:16
    s_mov_b64 exec, s[42:43]
    s_waitcnt lgkmcnt(0)
    s_barrier
    s_lshr_b32 s36, s7, 1
    s_lshl_b32 s36, s36, 2
    s_add_u32 s64, s64, s36
    s_addc_u32 s65, s65, 0
    s_load_dword s87, s[64:65], 0
    s_cmp_ge_u32 s4, 4
    s_cselect_b32 s66, s78, s66
    s_cselect_b32 s67, s79, s67
    s_add_u32 s66, s66, s36
    s_addc_u32 s67, s67, 0
    s_load_dword s84, s[66:67], 0
    s_lshl_b32 s52, s7, 12
    v_lshlrev_b32 v6, 4, v1
    v_add_u32 v6, s52, v6
    s_mul_i32 s53, s6, 4456448
    s_mul_i32 s41, s7, 4352
    v_lshlrev_b32 v143, 4, v1
    v_add_u32 v143, s41, v143
    s_cmp_ge_u32 s4, 4
    s_nop 3
    s_cbranch_scc1 L_Bloads
    s_mov_b32 s8, s44
    s_and_b32 s9, s45, 0xffff
    s_mov_b32 s10, 0x40000
    s_mov_b32 s11, 0x00020000
    s_mov_b32 s16, s46
    s_and_b32 s17, s47, 0xffff
    s_mov_b32 s18, 0x40000
    s_mov_b32 s19, 0x00020000
    s_mov_b32 s20, s48
    s_and_b32 s21, s49, 0xffff
    s_mov_b32 s22, 0x40000
    s_mov_b32 s23, 0x00020000
    s_mov_b32 s56, s50
    s_and_b32 s57, s51, 0xffff
    s_mov_b32 s58, 0x40000
    s_mov_b32 s59, 0x00020000
    s_lshl_b32 s41, s7, 8
    v_lshlrev_b32 v28, 1, v1
    v_add_u32 v28, s41, v28
    buffer_load_ushort v30, v28, s[8:11], 0 offen
    buffer_load_ushort v31, v28, s[16:19], 0 offen
    buffer_load_ushort v32, v28, s[20:23], 0 offen
    buffer_load_ushort v33, v28, s[56:59], 0 offen
    buffer_load_ushort v112, v28, s[8:11], 0 offen offset:128
    buffer_load_ushort v113, v28, s[16:19], 0 offen offset:128
    buffer_load_ushort v114, v28, s[20:23], 0 offen offset:128
    buffer_load_ushort v115, v28, s[56:59], 0 offen offset:128
    s_branch L_common
L_Bloads:
    s_mov_b32 s24, s76
    s_and_b32 s25, s77, 0xffff
    s_mov_b32 s26, 0x400000
    s_mov_b32 s27, 0x00020000
    buffer_load_dwordx4 v[96:99], v6, s[24:27], 0 offen offset:0
    buffer_load_dwordx4 v[100:103], v6, s[24:27], 0 offen offset:1024
    buffer_load_dwordx4 v[104:107], v6, s[24:27], 0 offen offset:2048
    buffer_load_dwordx4 v[108:111], v6, s[24:27], 0 offen offset:3072
    s_lshl_b32 s41, s3, 5
    s_add_u32 s74, s74, s41
    s_addc_u32 s75, s75, 0
    s_load_dwordx8 s[8:15], s[74:75], 0
    v_and_b32 v142, 255, v0
    v_lshlrev_b32 v120, 14, v142
    v_add_u32 v120, s5, v120
    v_subrev_u32 v122, 6144, v120
    v_subrev_u32 v123, 2048, v120
    s_mov_b32 s56, 0
    s_mov_b32 s57, 4096
    s_mov_b32 s58, 8192
    s_mov_b32 s59, 12288
    s_mov_b32 s16, s98
    s_and_b32 s17, s99, 0xffff
    s_mov_b32 s18, 0x400000
    s_mov_b32 s19, 0x00020000
    buffer_load_dwordx2 v[182:183], v120, s[16:19], s56 offen offset:0
    buffer_load_dwordx2 v[184:185], v120, s[16:19], s56 offen offset:2048
    buffer_load_dwordx2 v[186:187], v120, s[16:19], s57 offen offset:0
    buffer_load_dwordx2 v[188:189], v120, s[16:19], s57 offen offset:2048
    buffer_load_dwordx2 v[190:191], v120, s[16:19], s58 offen offset:0
    buffer_load_dwordx2 v[192:193], v120, s[16:19], s58 offen offset:2048
    buffer_load_dwordx2 v[194:195], v120, s[16:19], s59 offen offset:0
    buffer_load_dwordx2 v[196:197], v120, s[16:19], s59 offen offset:2048
    s_mov_b32 s16, s70
    s_and_b32 s17, s71, 0xffff
    s_mov_b32 s18, 0x400000
    s_mov_b32 s19, 0x00020000
    buffer_load_dwordx2 v[144:145], v122, s[16:19], 0 offen
    buffer_load_dwordx2 v[146:147], v122, s[16:19], 0 offen offset:2048
    buffer_load_dwordx2 v[148:149], v123, s[16:19], 0 offen
    buffer_load_dwordx2 v[150:151], v120, s[16:19], s56 offen offset:0
    buffer_load_dwordx2 v[152:153], v120, s[16:19], s56 offen offset:2048
    buffer_load_dwordx2 v[154:155], v120, s[16:19], s57 offen offset:0
    buffer_load_dwordx2 v[156:157], v120, s[16:19], s57 offen offset:2048
    buffer_load_dwordx2 v[158:159], v120, s[16:19], s58 offen offset:0
    buffer_load_dwordx2 v[160:161], v120, s[16:19], s58 offen offset:2048
    buffer_load_dwordx2 v[162:163], v120, s[16:19], s59 offen offset:0
    buffer_load_dwordx2 v[164:165], v120, s[16:19], s59 offen offset:2048
    s_mov_b32 s16, s72
    s_and_b32 s17, s73, 0xffff
    s_mov_b32 s18, 0x400000
    s_mov_b32 s19, 0x00020000
    s_waitcnt lgkmcnt(0)
    s_lshl_b32 s44, s8, 16
    s_and_b32 s45, s8, 0xffff0000
    s_lshl_b32 s46, s9, 16
    s_and_b32 s47, s9, 0xffff0000
    s_lshl_b32 s48, s10, 16
    s_and_b32 s49, s10, 0xffff0000
    s_lshl_b32 s50, s11, 16
    s_and_b32 s51, s11, 0xffff0000
    s_lshl_b32 s52, s12, 16
    s_and_b32 s53, s12, 0xffff0000
    s_lshl_b32 s54, s13, 16
    s_and_b32 s55, s13, 0xffff0000
    s_lshl_b32 s56, s14, 16
    s_and_b32 s57, s14, 0xffff0000
    s_lshl_b32 s58, s15, 16
    s_and_b32 s59, s15, 0xffff0000
L_common:
    s_mov_b32 s12, s68
    s_and_b32 s13, s69, 0xffff
    s_mov_b32 s14, 0x400000
    s_mov_b32 s15, 0x00020000
    s_mov_b32 s28, s80
    s_and_b32 s29, s81, 0xffff
    s_mov_b32 s30, 0x800000
    s_mov_b32 s31, 0x00020000
    s_mov_b32 s92, s82
    s_and_b32 s93, s83, 0xffff
    s_mov_b32 s94, 0x100
    s_mov_b32 s95, 0x00020000
    s_add_u32 s39, s38, 8480
    s_add_u32 s40, s38, 12640
    s_mov_b32 s100, 0x05040100
    s_mov_b32 s101, 0x07060302
    v_and_b32 v8, 1, v1
    v_lshlrev_b32 v8, 1, v8
    v_lshrrev_b32 v9, 4, v1
    v_lshrrev_b32 v126, 1, v1
    v_xor_b32 v9, v9, v126
    v_and_b32 v9, 1, v9
    v_add_u32 v8, v8, v9
    v_lshlrev_b32 v8, 4, v8
    v_lshrrev_b32 v9, 2, v1
    v_lshl_add_u32 v8, v9, 6, v8
    v_add_u32 v26, s40, v8
    v_lshlrev_b32 v27, 4, v1
    s_add_u32 s41, s39, 64
    v_add_u32 v27, s41, v27
    v_and_b32 v129, 15, v1
    v_lshrrev_b32 v125, 4, v1
    v_lshlrev_b32 v126, 3, v125
    v_sub_u32 v126, v126, v129
    v_add_u32 v126, 1023, v126
    v_lshrrev_b32 v127, 2, v126
    v_lshlrev_b32 v127, 5, v127
    v_and_b32 v126, 3, v126
    v_lshl_add_u32 v127, v126, 3, v127
    s_sub_u32 s41, s38, 4480
    v_add_u32 v130, s41, v127
    v_lshrrev_b32 v131, 1, v125
    v_and_b32 v126, 1, v125
    v_lshlrev_b32 v126, 5, v126
    v_lshrrev_b32 v127, 2, v129
    v_xor_b32 v127, v127, v131
    v_and_b32 v127, 1, v127
    v_lshl_add_u32 v126, v127, 4, v126
    v_lshl_add_u32 v126, v129, 6, v126
    v_add_u32 v132, s40, v126
    v_lshlrev_b32 v9, 6, v129
    v_lshl_add_u32 v9, v125, 3, v9
    s_add_u32 s41, s39, 64
    v_add_u32 v9, s41, v9
    v_lshlrev_b32 v126, 3, v1
    s_add_u32 s41, s39, 2096
    v_sub_u32 v138, s41, v126
    v_lshlrev_b32 v139, 5, v1
    v_add_u32 v139, s38, v139
    v_mov_b32 v140, 0xffff
    v_and_b32 v142, 255, v0
    v_lshlrev_b32 v7, 4, v142
    s_mul_i32 s41, s6, 24224
    s_add_u32 s41, s41, 8544
    v_add_u32 v7, s41, v7
    v_add_u32 v141, 81920, v7
    v_lshlrev_b32 v2, 14, v142
    v_add_u32 v2, s5, v2
    v_lshlrev_b32 v3, 15, v142
    s_lshl_b32 s41, s6, 11
    s_add_u32 s41, s41, s5
    v_add_u32 v3, s41, v3
    s_mov_b32 s68, 0
    s_mov_b32 s69, 4096
    s_mov_b32 s70, 8192
    s_mov_b32 s71, 12288
    s_mov_b32 s72, 16384
    s_mov_b32 s73, 20480
    s_mov_b32 s74, 24576
    s_mov_b32 s75, 28672
    s_waitcnt lgkmcnt(0)
    s_lshl_b32 s85, s84, 16
    s_and_b32 s86, s84, 0xffff0000
    s_lshl_b32 s88, s87, 16
    s_and_b32 s89, s87, 0xffff0000
    s_bitcmp1_b32 s7, 0
    s_cselect_b32 s85, s86, s85
    s_cselect_b32 s88, s89, s88
    s_cmp_ge_u32 s4, 4
    s_cbranch_scc1 L_B
    s_mov_b32 s60, 0x3fb8aa3b
    s_mov_b32 s61, 0x32a57060
    s_mov_b32 s62, 0x3f317218
    s_mov_b32 s63, 0x3e22f983
    s_mov_b32 s90, 0x31dc9c88
    v_mov_b32 v242, s88
    v_mul_f32 v240, s60, v242
    v_fma_f32 v241, v242, s60, -v240
    v_fma_f32 v241, v242, s61, v241
    v_exp_f32 v29, v240
    v_mul_f32 v241, s62, v241
    v_fma_f32 v29, v29, v241, v29
    v_cvt_pk_bf16_f32 v29, v29, v29
    v_lshlrev_b32 v29, 16, v29
    v_lshlrev_b32 v246, 2, v1
    v_add_u32 v246, s38, v246
    v_mul_u32_u24 v247, 544, v129
    v_lshrrev_b32 v240, 4, v1
    v_lshlrev_b32 v240, 4, v240
    v_add3_u32 v247, v247, v240, s38
    v_mov_b32 v144, 0
    v_mov_b32 v145, 0
    v_mov_b32 v146, 0
    v_mov_b32 v147, 0
    v_mov_b32 v148, 0
    v_mov_b32 v149, 0
    v_mov_b32 v150, 0
    v_mov_b32 v151, 0
    v_mov_b32 v152, 0
    v_mov_b32 v153, 0
    v_mov_b32 v154, 0
    v_mov_b32 v155, 0
    v_mov_b32 v194, 1.0
    v_mov_b32 v195, 0
    s_waitcnt vmcnt(0)
    s_mov_b32 s97, 2
    s_nop 2
Lhalf_1:
    v_lshlrev_b32 v30, 16, v30
    v_lshlrev_b32 v31, 16, v31
    v_lshlrev_b32 v32, 16, v32
    v_lshlrev_b32 v33, 16, v33
    v_mul_f32 v240, s60, v30
    v_fma_f32 v241, v30, s60, -v240
    v_fma_f32 v241, v30, s61, v241
    v_exp_f32 v243, v240
    v_mul_f32 v241, s62, v241
    v_fma_f32 v243, v243, v241, v243
    v_cvt_pk_bf16_f32 v243, v243, v243
    v_lshlrev_b32 v243, 16, v243
    v_mul_f32 v38, -v243, v29
    v_mul_f32 v39, v31, v29
    v_mul_f32 v36, v32, v29
    v_mul_f32 v37, v33, v29
    v_add_f32 v36, v36, v36
    v_add_f32 v37, v37, v37
    v_mul_f32 v50, 0x3f800000, v38
    v_mul_f32 v54, 0x41000000, v38
    v_mul_f32 v58, 0x43000000, v38
    v_mul_f32 v62, 0x43800000, v38
    v_mul_f32 v66, 0x44000000, v38
    v_mul_f32 v70, 0x44800000, v38
    v_mul_f32 v48, s60, v50
    v_mul_f32 v52, s60, v54
    v_mul_f32 v56, s60, v58
    v_mul_f32 v60, s60, v62
    v_mul_f32 v64, s60, v66
    v_mul_f32 v68, s60, v70
    v_fma_f32 v49, v50, s60, -v48
    v_fma_f32 v53, v54, s60, -v52
    v_fma_f32 v57, v58, s60, -v56
    v_fma_f32 v61, v62, s60, -v60
    v_fma_f32 v65, v66, s60, -v64
    v_fma_f32 v69, v70, s60, -v68
    v_fma_f32 v49, v50, s61, v49
    v_fma_f32 v53, v54, s61, v53
    v_fma_f32 v57, v58, s61, v57
    v_fma_f32 v61, v62, s61, v61
    v_fma_f32 v65, v66, s61, v65
    v_fma_f32 v69, v70, s61, v69
    v_exp_f32 v51, v48
    v_exp_f32 v55, v52
    v_exp_f32 v59, v56
    v_exp_f32 v63, v60
    v_exp_f32 v67, v64
    v_exp_f32 v71, v68
    v_mul_f32 v49, s62, v49
    v_mul_f32 v53, s62, v53
    v_mul_f32 v57, s62, v57
    v_mul_f32 v61, s62, v61
    v_mul_f32 v65, s62, v65
    v_mul_f32 v69, s62, v69
    v_mul_f32 v50, 0x3f800000, v39
    v_mul_f32 v54, 0x41000000, v39
    v_mul_f32 v58, 0x43000000, v39
    v_mul_f32 v62, 0x43800000, v39
    v_mul_f32 v66, 0x44000000, v39
    v_mul_f32 v70, 0x44800000, v39
    v_fma_f32 v51, v51, v49, v51
    v_fma_f32 v55, v55, v53, v55
    v_fma_f32 v59, v59, v57, v59
    v_fma_f32 v63, v63, v61, v63
    v_fma_f32 v67, v67, v65, v67
    v_fma_f32 v71, v71, v69, v71
    v_mul_f32 v48, s63, v50
    v_mul_f32 v52, s63, v54
    v_mul_f32 v56, s63, v58
    v_mul_f32 v60, s63, v62
    v_mul_f32 v64, s63, v66
    v_mul_f32 v68, s63, v70
    v_fma_f32 v49, v50, s63, -v48
    v_fma_f32 v53, v54, s63, -v52
    v_fma_f32 v57, v58, s63, -v56
    v_fma_f32 v61, v62, s63, -v60
    v_fma_f32 v65, v66, s63, -v64
    v_fma_f32 v69, v70, s63, -v68
    v_fma_f32 v49, v50, s90, v49
    v_fma_f32 v53, v54, s90, v53
    v_fma_f32 v57, v58, s90, v57
    v_fma_f32 v61, v62, s90, v61
    v_fma_f32 v65, v66, s90, v65
    v_fma_f32 v69, v70, s90, v69
    v_fract_f32 v48, v48
    v_fract_f32 v52, v52
    v_fract_f32 v56, v56
    v_fract_f32 v60, v60
    v_fract_f32 v64, v64
    v_fract_f32 v68, v68
    v_add_f32 v48, v48, v49
    v_add_f32 v52, v52, v53
    v_add_f32 v56, v56, v57
    v_add_f32 v60, v60, v61
    v_add_f32 v64, v64, v65
    v_add_f32 v68, v68, v69
    v_cos_f32 v160, v48
    v_cos_f32 v166, v52
    v_cos_f32 v168, v56
    v_cos_f32 v170, v60
    v_cos_f32 v172, v64
    v_cos_f32 v174, v68
    v_sin_f32 v161, v48
    v_sin_f32 v167, v52
    v_sin_f32 v169, v56
    v_sin_f32 v171, v60
    v_sin_f32 v173, v64
    v_sin_f32 v175, v68
    v_mul_f32 v160, v160, v51
    v_mul_f32 v166, v166, v55
    v_mul_f32 v168, v168, v59
    v_mul_f32 v170, v170, v63
    v_mul_f32 v172, v172, v67
    v_mul_f32 v174, v174, v71
    v_mul_f32 v161, v161, v51
    v_mul_f32 v167, v167, v55
    v_mul_f32 v169, v169, v59
    v_mul_f32 v171, v171, v63
    v_mul_f32 v173, v173, v67
    v_mul_f32 v175, v175, v71
    v_pk_mul_f32 v[48:49], v[160:161], v[160:161] op_sel:[0,0] op_sel_hi:[0,1]
    v_pk_mul_f32 v[50:51], v[36:37], v[168:169] op_sel:[0,0] op_sel_hi:[0,1]
    v_pk_mul_f32 v[52:53], v[36:37], v[170:171] op_sel:[0,0] op_sel_hi:[0,1]
    v_pk_mul_f32 v[54:55], v[36:37], v[172:173] op_sel:[0,0] op_sel_hi:[0,1]
    v_pk_mul_f32 v[56:57], v[36:37], v[174:175] op_sel:[0,0] op_sel_hi:[0,1]
    v_pk_mul_f32 v[58:59], v[166:167], v[166:167] op_sel:[0,0] op_sel_hi:[0,1]
    v_pk_mul_f32 v[60:61], v[168:169], v[168:169] op_sel:[0,0] op_sel_hi:[0,1]
    v_pk_fma_f32 v[162:163], v[160:161], v[160:161], v[48:49] op_sel:[1,1,0] op_sel_hi:[1,0,1] neg_lo:[1,0,0] neg_hi:[0,0,0]
    v_pk_fma_f32 v[176:177], v[36:37], v[168:169], v[50:51] op_sel:[1,1,0] op_sel_hi:[1,0,1] neg_lo:[1,0,0] neg_hi:[0,0,0]
    v_pk_fma_f32 v[178:179], v[36:37], v[170:171], v[52:53] op_sel:[1,1,0] op_sel_hi:[1,0,1] neg_lo:[1,0,0] neg_hi:[0,0,0]
    v_pk_fma_f32 v[182:183], v[36:37], v[172:173], v[54:55] op_sel:[1,1,0] op_sel_hi:[1,0,1] neg_lo:[1,0,0] neg_hi:[0,0,0]
    v_pk_fma_f32 v[184:185], v[36:37], v[174:175], v[56:57] op_sel:[1,1,0] op_sel_hi:[1,0,1] neg_lo:[1,0,0] neg_hi:[0,0,0]
    v_pk_fma_f32 v[186:187], v[166:167], v[166:167], v[58:59] op_sel:[1,1,0] op_sel_hi:[1,0,1] neg_lo:[1,0,0] neg_hi:[0,0,0]
    v_pk_fma_f32 v[192:193], v[168:169], v[168:169], v[60:61] op_sel:[1,1,0] op_sel_hi:[1,0,1] neg_lo:[1,0,0] neg_hi:[0,0,0]
    v_pk_mul_f32 v[48:49], v[162:163], v[162:163] op_sel:[0,0] op_sel_hi:[0,1]
    v_pk_mul_f32 v[50:51], v[178:179], v[168:169] op_sel:[0,0] op_sel_hi:[0,1]
    v_pk_mul_f32 v[52:53], v[186:187], v[186:187] op_sel:[0,0] op_sel_hi:[0,1]
    v_pk_mul_f32 v[54:55], v[184:185], v[166:167] op_sel:[0,0] op_sel_hi:[0,1]
    v_pk_fma_f32 v[164:165], v[162:163], v[162:163], v[48:49] op_sel:[1,1,0] op_sel_hi:[1,0,1] neg_lo:[1,0,0] neg_hi:[0,0,0]
    v_pk_fma_f32 v[180:181], v[178:179], v[168:169], v[50:51] op_sel:[1,1,0] op_sel_hi:[1,0,1] neg_lo:[1,0,0] neg_hi:[0,0,0]
    v_pk_fma_f32 v[188:189], v[186:187], v[186:187], v[52:53] op_sel:[1,1,0] op_sel_hi:[1,0,1] neg_lo:[1,0,0] neg_hi:[0,0,0]
    v_pk_fma_f32 v[184:185], v[184:185], v[166:167], v[54:55] op_sel:[1,1,0] op_sel_hi:[1,0,1] neg_lo:[1,0,0] neg_hi:[0,0,0]
    v_pk_mul_f32 v[48:49], v[188:189], v[188:189] op_sel:[0,0] op_sel_hi:[0,1]
    s_nop 0
    v_pk_fma_f32 v[190:191], v[188:189], v[188:189], v[48:49] op_sel:[1,1,0] op_sel_hi:[1,0,1] neg_lo:[1,0,0] neg_hi:[0,0,0]
    v_mov_b32 v48, v194
    v_mov_b32 v60, v188
    v_mov_b32 v72, v190
    v_pk_mul_f32 v[88:89], v[190:191], v[188:189] op_sel:[0,0] op_sel_hi:[0,1]
    v_mov_b32 v49, v195
    v_mov_b32 v61, v189
    v_mov_b32 v73, v191
    v_pk_fma_f32 v[84:85], v[190:191], v[188:189], v[88:89] op_sel:[1,1,0] op_sel_hi:[1,0,1] neg_lo:[1,0,0] neg_hi:[0,0,0]
    v_add_u32 v58, 0, v246
    v_add_u32 v70, 2176, v246
    v_add_u32 v82, 4352, v246
    v_add_u32 v94, 6528, v246
    s_mov_b32 s96, 2
Lch_2:
    v_pk_mul_f32 v[52:53], v[48:49], v[166:167] op_sel:[0,0] op_sel_hi:[0,1]
    v_pk_mul_f32 v[64:65], v[60:61], v[166:167] op_sel:[0,0] op_sel_hi:[0,1]
    v_pk_mul_f32 v[76:77], v[72:73], v[166:167] op_sel:[0,0] op_sel_hi:[0,1]
    v_pk_mul_f32 v[88:89], v[84:85], v[166:167] op_sel:[0,0] op_sel_hi:[0,1]
    v_pk_fma_f32 v[50:51], v[48:49], v[166:167], v[52:53] op_sel:[1,1,0] op_sel_hi:[1,0,1] neg_lo:[1,0,0] neg_hi:[0,0,0]
    v_pk_fma_f32 v[62:63], v[60:61], v[166:167], v[64:65] op_sel:[1,1,0] op_sel_hi:[1,0,1] neg_lo:[1,0,0] neg_hi:[0,0,0]
    v_pk_fma_f32 v[74:75], v[72:73], v[166:167], v[76:77] op_sel:[1,1,0] op_sel_hi:[1,0,1] neg_lo:[1,0,0] neg_hi:[0,0,0]
    v_pk_fma_f32 v[86:87], v[84:85], v[166:167], v[88:89] op_sel:[1,1,0] op_sel_hi:[1,0,1] neg_lo:[1,0,0] neg_hi:[0,0,0]
    v_cvt_pk_bf16_f32 v56, v48, v49
    v_cvt_pk_bf16_f32 v68, v60, v61
    v_cvt_pk_bf16_f32 v80, v72, v73
    v_cvt_pk_bf16_f32 v92, v84, v85
    v_lshlrev_b32 v54, 16, v56
    v_lshlrev_b32 v66, 16, v68
    v_lshlrev_b32 v78, 16, v80
    v_lshlrev_b32 v90, 16, v92
    v_and_b32 v55, 0xffff0000, v56
    v_and_b32 v67, 0xffff0000, v68
    v_and_b32 v79, 0xffff0000, v80
    v_and_b32 v91, 0xffff0000, v92
    v_pk_add_f32 v[54:55], v[48:49], v[54:55] neg_lo:[0,1] neg_hi:[0,1]
    v_pk_add_f32 v[66:67], v[60:61], v[66:67] neg_lo:[0,1] neg_hi:[0,1]
    v_pk_add_f32 v[78:79], v[72:73], v[78:79] neg_lo:[0,1] neg_hi:[0,1]
    v_pk_add_f32 v[90:91], v[84:85], v[90:91] neg_lo:[0,1] neg_hi:[0,1]
    v_cvt_pk_bf16_f32 v57, v54, v55
    v_cvt_pk_bf16_f32 v69, v66, v67
    v_cvt_pk_bf16_f32 v81, v78, v79
    v_cvt_pk_bf16_f32 v93, v90, v91
    ds_write2_b32 v58, v56, v57 offset0:0 offset1:64
    ds_write2_b32 v70, v68, v69 offset0:0 offset1:64
    ds_write2_b32 v82, v80, v81 offset0:0 offset1:64
    ds_write2_b32 v94, v92, v93 offset0:0 offset1:64
    v_add_u32 v58, 544, v58
    v_add_u32 v70, 544, v70
    v_add_u32 v82, 544, v82
    v_add_u32 v94, 544, v94
    v_pk_mul_f32 v[52:53], v[50:51], v[166:167] op_sel:[0,0] op_sel_hi:[0,1]
    v_pk_mul_f32 v[64:65], v[62:63], v[166:167] op_sel:[0,0] op_sel_hi:[0,1]
    v_pk_mul_f32 v[76:77], v[74:75], v[166:167] op_sel:[0,0] op_sel_hi:[0,1]
    v_pk_mul_f32 v[88:89], v[86:87], v[166:167] op_sel:[0,0] op_sel_hi:[0,1]
    v_pk_fma_f32 v[48:49], v[50:51], v[166:167], v[52:53] op_sel:[1,1,0] op_sel_hi:[1,0,1] neg_lo:[1,0,0] neg_hi:[0,0,0]
    v_pk_fma_f32 v[60:61], v[62:63], v[166:167], v[64:65] op_sel:[1,1,0] op_sel_hi:[1,0,1] neg_lo:[1,0,0] neg_hi:[0,0,0]
    v_pk_fma_f32 v[72:73], v[74:75], v[166:167], v[76:77] op_sel:[1,1,0] op_sel_hi:[1,0,1] neg_lo:[1,0,0] neg_hi:[0,0,0]
    v_pk_fma_f32 v[84:85], v[86:87], v[166:167], v[88:89] op_sel:[1,1,0] op_sel_hi:[1,0,1] neg_lo:[1,0,0] neg_hi:[0,0,0]
    v_cvt_pk_bf16_f32 v56, v50, v51
    v_cvt_pk_bf16_f32 v68, v62, v63
    v_cvt_pk_bf16_f32 v80, v74, v75
    v_cvt_pk_bf16_f32 v92, v86, v87
    v_lshlrev_b32 v54, 16, v56
    v_lshlrev_b32 v66, 16, v68
    v_lshlrev_b32 v78, 16, v80
    v_lshlrev_b32 v90, 16, v92
    v_and_b32 v55, 0xffff0000, v56
    v_and_b32 v67, 0xffff0000, v68
    v_and_b32 v79, 0xffff0000, v80
    v_and_b32 v91, 0xffff0000, v92
    v_pk_add_f32 v[54:55], v[50:51], v[54:55] neg_lo:[0,1] neg_hi:[0,1]
    v_pk_add_f32 v[66:67], v[62:63], v[66:67] neg_lo:[0,1] neg_hi:[0,1]
    v_pk_add_f32 v[78:79], v[74:75], v[78:79] neg_lo:[0,1] neg_hi:[0,1]
    v_pk_add_f32 v[90:91], v[86:87], v[90:91] neg_lo:[0,1] neg_hi:[0,1]
    v_cvt_pk_bf16_f32 v57, v54, v55
    v_cvt_pk_bf16_f32 v69, v66, v67
    v_cvt_pk_bf16_f32 v81, v78, v79
    v_cvt_pk_bf16_f32 v93, v90, v91
    ds_write2_b32 v58, v56, v57 offset0:0 offset1:64
    ds_write2_b32 v70, v68, v69 offset0:0 offset1:64
    ds_write2_b32 v82, v80, v81 offset0:0 offset1:64
    ds_write2_b32 v94, v92, v93 offset0:0 offset1:64
    v_add_u32 v58, 544, v58
    v_add_u32 v70, 544, v70
    v_add_u32 v82, 544, v82
    v_add_u32 v94, 544, v94
    s_sub_u32 s96, s96, 1
    s_cmp_lg_u32 s96, 0
    s_cbranch_scc1 Lch_2
    v_mov_b32 v48, v36
    v_pk_mul_f32 v[64:65], v[36:37], v[164:165] op_sel:[0,0] op_sel_hi:[0,1]
    v_mov_b32 v72, v176
    v_pk_mul_f32 v[88:89], v[176:177], v[164:165] op_sel:[0,0] op_sel_hi:[0,1]
    v_mov_b32 v49, v37
    v_pk_fma_f32 v[60:61], v[36:37], v[164:165], v[64:65] op_sel:[1,1,0] op_sel_hi:[1,0,1] neg_lo:[1,0,0] neg_hi:[0,0,0]
    v_mov_b32 v73, v177
    v_pk_fma_f32 v[84:85], v[176:177], v[164:165], v[88:89] op_sel:[1,1,0] op_sel_hi:[1,0,1] neg_lo:[1,0,0] neg_hi:[0,0,0]
    v_add_u32 v58, 8704, v246
    v_add_u32 v70, 10880, v246
    v_add_u32 v82, 13056, v246
    v_add_u32 v94, 15232, v246
    s_mov_b32 s96, 2
Lch_3:
    v_pk_mul_f32 v[52:53], v[48:49], v[160:161] op_sel:[0,0] op_sel_hi:[0,1]
    v_pk_mul_f32 v[64:65], v[60:61], v[160:161] op_sel:[0,0] op_sel_hi:[0,1]
    v_pk_mul_f32 v[76:77], v[72:73], v[160:161] op_sel:[0,0] op_sel_hi:[0,1]
    v_pk_mul_f32 v[88:89], v[84:85], v[160:161] op_sel:[0,0] op_sel_hi:[0,1]
    v_pk_fma_f32 v[50:51], v[48:49], v[160:161], v[52:53] op_sel:[1,1,0] op_sel_hi:[1,0,1] neg_lo:[1,0,0] neg_hi:[0,0,0]
    v_pk_fma_f32 v[62:63], v[60:61], v[160:161], v[64:65] op_sel:[1,1,0] op_sel_hi:[1,0,1] neg_lo:[1,0,0] neg_hi:[0,0,0]
    v_pk_fma_f32 v[74:75], v[72:73], v[160:161], v[76:77] op_sel:[1,1,0] op_sel_hi:[1,0,1] neg_lo:[1,0,0] neg_hi:[0,0,0]
    v_pk_fma_f32 v[86:87], v[84:85], v[160:161], v[88:89] op_sel:[1,1,0] op_sel_hi:[1,0,1] neg_lo:[1,0,0] neg_hi:[0,0,0]
    v_cvt_pk_bf16_f32 v56, v48, -v49
    v_cvt_pk_bf16_f32 v68, v60, -v61
    v_cvt_pk_bf16_f32 v80, v72, -v73
    v_cvt_pk_bf16_f32 v92, v84, -v85
    v_lshlrev_b32 v54, 16, v56
    v_lshlrev_b32 v66, 16, v68
    v_lshlrev_b32 v78, 16, v80
    v_lshlrev_b32 v90, 16, v92
    v_and_b32 v55, 0xffff0000, v56
    v_and_b32 v67, 0xffff0000, v68
    v_and_b32 v79, 0xffff0000, v80
    v_and_b32 v91, 0xffff0000, v92
    v_pk_add_f32 v[54:55], v[48:49], v[54:55] neg_lo:[0,1] neg_hi:[1,1]
    v_pk_add_f32 v[66:67], v[60:61], v[66:67] neg_lo:[0,1] neg_hi:[1,1]
    v_pk_add_f32 v[78:79], v[72:73], v[78:79] neg_lo:[0,1] neg_hi:[1,1]
    v_pk_add_f32 v[90:91], v[84:85], v[90:91] neg_lo:[0,1] neg_hi:[1,1]
    v_cvt_pk_bf16_f32 v57, v54, v55
    v_cvt_pk_bf16_f32 v69, v66, v67
    v_cvt_pk_bf16_f32 v81, v78, v79
    v_cvt_pk_bf16_f32 v93, v90, v91
    ds_write2_b32 v58, v56, v57 offset0:0 offset1:64
    ds_write2_b32 v70, v68, v69 offset0:0 offset1:64
    ds_write2_b32 v82, v80, v81 offset0:0 offset1:64
    ds_write2_b32 v94, v92, v93 offset0:0 offset1:64
    v_add_u32 v58, 544, v58
    v_add_u32 v70, 544, v70
    v_add_u32 v82, 544, v82
    v_add_u32 v94, 544, v94
    v_pk_mul_f32 v[52:53], v[50:51], v[160:161] op_sel:[0,0] op_sel_hi:[0,1]
    v_pk_mul_f32 v[64:65], v[62:63], v[160:161] op_sel:[0,0] op_sel_hi:[0,1]
    v_pk_mul_f32 v[76:77], v[74:75], v[160:161] op_sel:[0,0] op_sel_hi:[0,1]
    v_pk_mul_f32 v[88:89], v[86:87], v[160:161] op_sel:[0,0] op_sel_hi:[0,1]
    v_pk_fma_f32 v[48:49], v[50:51], v[160:161], v[52:53] op_sel:[1,1,0] op_sel_hi:[1,0,1] neg_lo:[1,0,0] neg_hi:[0,0,0]
    v_pk_fma_f32 v[60:61], v[62:63], v[160:161], v[64:65] op_sel:[1,1,0] op_sel_hi:[1,0,1] neg_lo:[1,0,0] neg_hi:[0,0,0]
    v_pk_fma_f32 v[72:73], v[74:75], v[160:161], v[76:77] op_sel:[1,1,0] op_sel_hi:[1,0,1] neg_lo:[1,0,0] neg_hi:[0,0,0]
    v_pk_fma_f32 v[84:85], v[86:87], v[160:161], v[88:89] op_sel:[1,1,0] op_sel_hi:[1,0,1] neg_lo:[1,0,0] neg_hi:[0,0,0]
    v_cvt_pk_bf16_f32 v56, v50, -v51
    v_cvt_pk_bf16_f32 v68, v62, -v63
    v_cvt_pk_bf16_f32 v80, v74, -v75
    v_cvt_pk_bf16_f32 v92, v86, -v87
    v_lshlrev_b32 v54, 16, v56
    v_lshlrev_b32 v66, 16, v68
    v_lshlrev_b32 v78, 16, v80
    v_lshlrev_b32 v90, 16, v92
    v_and_b32 v55, 0xffff0000, v56
    v_and_b32 v67, 0xffff0000, v68
    v_and_b32 v79, 0xffff0000, v80
    v_and_b32 v91, 0xffff0000, v92
    v_pk_add_f32 v[54:55], v[50:51], v[54:55] neg_lo:[0,1] neg_hi:[1,1]
    v_pk_add_f32 v[66:67], v[62:63], v[66:67] neg_lo:[0,1] neg_hi:[1,1]
    v_pk_add_f32 v[78:79], v[74:75], v[78:79] neg_lo:[0,1] neg_hi:[1,1]
    v_pk_add_f32 v[90:91], v[86:87], v[90:91] neg_lo:[0,1] neg_hi:[1,1]
    v_cvt_pk_bf16_f32 v57, v54, v55
    v_cvt_pk_bf16_f32 v69, v66, v67
    v_cvt_pk_bf16_f32 v81, v78, v79
    v_cvt_pk_bf16_f32 v93, v90, v91
    ds_write2_b32 v58, v56, v57 offset0:0 offset1:64
    ds_write2_b32 v70, v68, v69 offset0:0 offset1:64
    ds_write2_b32 v82, v80, v81 offset0:0 offset1:64
    ds_write2_b32 v94, v92, v93 offset0:0 offset1:64
    v_add_u32 v58, 544, v58
    v_add_u32 v70, 544, v70
    v_add_u32 v82, 544, v82
    v_add_u32 v94, 544, v94
    s_sub_u32 s96, s96, 1
    s_cmp_lg_u32 s96, 0
    s_cbranch_scc1 Lch_3
    ds_read_b128 v[216:219], v247 offset:8704
    ds_read_b128 v[10:13], v247 offset:8960
    ds_read_b128 v[220:223], v247 offset:8768
    ds_read_b128 v[14:17], v247 offset:9024
    ds_read_b128 v[224:227], v247 offset:8832
    ds_read_b128 v[18:21], v247 offset:9088
    ds_read_b128 v[228:231], v247 offset:8896
    ds_read_b128 v[22:25], v247 offset:9152
    ds_read_b128 v[96:99], v247 offset:0
    ds_read_b128 v[196:199], v247 offset:256
    ds_read_b128 v[100:103], v247 offset:64
    ds_read_b128 v[200:203], v247 offset:320
    ds_read_b128 v[104:107], v247 offset:128
    ds_read_b128 v[204:207], v247 offset:384
    ds_read_b128 v[108:111], v247 offset:192
    ds_read_b128 v[208:211], v247 offset:448
    s_waitcnt lgkmcnt(0)
    v_mfma_f32_16x16x32_bf16 v[144:147], v[10:13], v[96:99], v[144:147]
    v_mfma_f32_16x16x32_bf16 v[144:147], v[216:219], v[196:199], v[144:147]
    v_mfma_f32_16x16x32_bf16 v[144:147], v[216:219], v[96:99], v[144:147]
    v_mfma_f32_16x16x32_bf16 v[144:147], v[14:17], v[100:103], v[144:147]
    v_mfma_f32_16x16x32_bf16 v[144:147], v[220:223], v[200:203], v[144:147]
    v_mfma_f32_16x16x32_bf16 v[144:147], v[220:223], v[100:103], v[144:147]
    v_mfma_f32_16x16x32_bf16 v[144:147], v[18:21], v[104:107], v[144:147]
    v_mfma_f32_16x16x32_bf16 v[144:147], v[224:227], v[204:207], v[144:147]
    v_mfma_f32_16x16x32_bf16 v[144:147], v[224:227], v[104:107], v[144:147]
    v_mfma_f32_16x16x32_bf16 v[144:147], v[22:25], v[108:111], v[144:147]
    v_mfma_f32_16x16x32_bf16 v[144:147], v[228:231], v[208:211], v[144:147]
    v_mfma_f32_16x16x32_bf16 v[144:147], v[228:231], v[108:111], v[144:147]
    v_pk_mul_f32 v[52:53], v[178:179], v[162:163] op_sel:[0,0] op_sel_hi:[0,1]
    v_pk_mul_f32 v[64:65], v[180:181], v[162:163] op_sel:[0,0] op_sel_hi:[0,1]
    v_pk_mul_f32 v[76:77], v[182:183], v[164:165] op_sel:[0,0] op_sel_hi:[0,1]
    v_pk_mul_f32 v[88:89], v[182:183], v[166:167] op_sel:[0,0] op_sel_hi:[0,1]
    v_pk_fma_f32 v[48:49], v[178:179], v[162:163], v[52:53] op_sel:[1,1,0] op_sel_hi:[1,0,1] neg_lo:[1,0,0] neg_hi:[0,0,0]
    v_pk_fma_f32 v[60:61], v[180:181], v[162:163], v[64:65] op_sel:[1,1,0] op_sel_hi:[1,0,1] neg_lo:[1,0,0] neg_hi:[0,0,0]
    v_pk_fma_f32 v[72:73], v[182:183], v[164:165], v[76:77] op_sel:[1,1,0] op_sel_hi:[1,0,1] neg_lo:[1,0,0] neg_hi:[0,0,0]
    v_pk_fma_f32 v[84:85], v[182:183], v[166:167], v[88:89] op_sel:[1,1,0] op_sel_hi:[1,0,1] neg_lo:[1,0,0] neg_hi:[0,0,0]
    v_add_u32 v58, 8704, v246
    v_add_u32 v70, 10880, v246
    v_add_u32 v82, 13056, v246
    v_add_u32 v94, 13600, v246
    s_mov_b32 s96, 2
Lch_4:
    v_pk_mul_f32 v[52:53], v[48:49], v[162:163] op_sel:[0,0] op_sel_hi:[0,1]
    v_pk_mul_f32 v[64:65], v[60:61], v[162:163] op_sel:[0,0] op_sel_hi:[0,1]
    v_pk_mul_f32 v[76:77], v[72:73], v[168:169] op_sel:[0,0] op_sel_hi:[0,1]
    v_pk_mul_f32 v[88:89], v[84:85], v[168:169] op_sel:[0,0] op_sel_hi:[0,1]
    v_pk_fma_f32 v[50:51], v[48:49], v[162:163], v[52:53] op_sel:[1,1,0] op_sel_hi:[1,0,1] neg_lo:[1,0,0] neg_hi:[0,0,0]
    v_pk_fma_f32 v[62:63], v[60:61], v[162:163], v[64:65] op_sel:[1,1,0] op_sel_hi:[1,0,1] neg_lo:[1,0,0] neg_hi:[0,0,0]
    v_pk_fma_f32 v[74:75], v[72:73], v[168:169], v[76:77] op_sel:[1,1,0] op_sel_hi:[1,0,1] neg_lo:[1,0,0] neg_hi:[0,0,0]
    v_pk_fma_f32 v[86:87], v[84:85], v[168:169], v[88:89] op_sel:[1,1,0] op_sel_hi:[1,0,1] neg_lo:[1,0,0] neg_hi:[0,0,0]
    v_cvt_pk_bf16_f32 v56, v48, -v49
    v_cvt_pk_bf16_f32 v68, v60, -v61
    v_cvt_pk_bf16_f32 v80, v72, -v73
    v_cvt_pk_bf16_f32 v92, v84, -v85
    v_lshlrev_b32 v54, 16, v56
    v_lshlrev_b32 v66, 16, v68
    v_lshlrev_b32 v78, 16, v80
    v_lshlrev_b32 v90, 16, v92
    v_and_b32 v55, 0xffff0000, v56
    v_and_b32 v67, 0xffff0000, v68
    v_and_b32 v79, 0xffff0000, v80
    v_and_b32 v91, 0xffff0000, v92
    v_pk_add_f32 v[54:55], v[48:49], v[54:55] neg_lo:[0,1] neg_hi:[1,1]
    v_pk_add_f32 v[66:67], v[60:61], v[66:67] neg_lo:[0,1] neg_hi:[1,1]
    v_pk_add_f32 v[78:79], v[72:73], v[78:79] neg_lo:[0,1] neg_hi:[1,1]
    v_pk_add_f32 v[90:91], v[84:85], v[90:91] neg_lo:[0,1] neg_hi:[1,1]
    v_cvt_pk_bf16_f32 v57, v54, v55
    v_cvt_pk_bf16_f32 v69, v66, v67
    v_cvt_pk_bf16_f32 v81, v78, v79
    v_cvt_pk_bf16_f32 v93, v90, v91
    ds_write2_b32 v58, v56, v57 offset0:0 offset1:64
    ds_write2_b32 v70, v68, v69 offset0:0 offset1:64
    ds_write2_b32 v82, v80, v81 offset0:0 offset1:64
    ds_write2_b32 v94, v92, v93 offset0:0 offset1:64
    v_add_u32 v58, 544, v58
    v_add_u32 v70, 544, v70
    v_add_u32 v82, 1088, v82
    v_add_u32 v94, 1088, v94
    v_pk_mul_f32 v[52:53], v[50:51], v[162:163] op_sel:[0,0] op_sel_hi:[0,1]
    v_pk_mul_f32 v[64:65], v[62:63], v[162:163] op_sel:[0,0] op_sel_hi:[0,1]
    v_pk_mul_f32 v[76:77], v[74:75], v[168:169] op_sel:[0,0] op_sel_hi:[0,1]
    v_pk_mul_f32 v[88:89], v[86:87], v[168:169] op_sel:[0,0] op_sel_hi:[0,1]
    v_pk_fma_f32 v[48:49], v[50:51], v[162:163], v[52:53] op_sel:[1,1,0] op_sel_hi:[1,0,1] neg_lo:[1,0,0] neg_hi:[0,0,0]
    v_pk_fma_f32 v[60:61], v[62:63], v[162:163], v[64:65] op_sel:[1,1,0] op_sel_hi:[1,0,1] neg_lo:[1,0,0] neg_hi:[0,0,0]
    v_pk_fma_f32 v[72:73], v[74:75], v[168:169], v[76:77] op_sel:[1,1,0] op_sel_hi:[1,0,1] neg_lo:[1,0,0] neg_hi:[0,0,0]
    v_pk_fma_f32 v[84:85], v[86:87], v[168:169], v[88:89] op_sel:[1,1,0] op_sel_hi:[1,0,1] neg_lo:[1,0,0] neg_hi:[0,0,0]
    v_cvt_pk_bf16_f32 v56, v50, -v51
    v_cvt_pk_bf16_f32 v68, v62, -v63
    v_cvt_pk_bf16_f32 v80, v74, -v75
    v_cvt_pk_bf16_f32 v92, v86, -v87
    v_lshlrev_b32 v54, 16, v56
    v_lshlrev_b32 v66, 16, v68
    v_lshlrev_b32 v78, 16, v80
    v_lshlrev_b32 v90, 16, v92
    v_and_b32 v55, 0xffff0000, v56
    v_and_b32 v67, 0xffff0000, v68
    v_and_b32 v79, 0xffff0000, v80
    v_and_b32 v91, 0xffff0000, v92
    v_pk_add_f32 v[54:55], v[50:51], v[54:55] neg_lo:[0,1] neg_hi:[1,1]
    v_pk_add_f32 v[66:67], v[62:63], v[66:67] neg_lo:[0,1] neg_hi:[1,1]
    v_pk_add_f32 v[78:79], v[74:75], v[78:79] neg_lo:[0,1] neg_hi:[1,1]
    v_pk_add_f32 v[90:91], v[86:87], v[90:91] neg_lo:[0,1] neg_hi:[1,1]
    v_cvt_pk_bf16_f32 v57, v54, v55
    v_cvt_pk_bf16_f32 v69, v66, v67
    v_cvt_pk_bf16_f32 v81, v78, v79
    v_cvt_pk_bf16_f32 v93, v90, v91
    ds_write2_b32 v58, v56, v57 offset0:0 offset1:64
    ds_write2_b32 v70, v68, v69 offset0:0 offset1:64
    ds_write2_b32 v82, v80, v81 offset0:0 offset1:64
    ds_write2_b32 v94, v92, v93 offset0:0 offset1:64
    v_add_u32 v58, 544, v58
    v_add_u32 v70, 544, v70
    v_add_u32 v82, 1088, v82
    v_add_u32 v94, 1088, v94
    s_sub_u32 s96, s96, 1
    s_cmp_lg_u32 s96, 0
    s_cbranch_scc1 Lch_4
    ds_read_b128 v[216:219], v247 offset:8704
    ds_read_b128 v[10:13], v247 offset:8960
    ds_read_b128 v[220:223], v247 offset:8768
    ds_read_b128 v[14:17], v247 offset:9024
    ds_read_b128 v[224:227], v247 offset:8832
    ds_read_b128 v[18:21], v247 offset:9088
    ds_read_b128 v[228:231], v247 offset:8896
    ds_read_b128 v[22:25], v247 offset:9152
    s_waitcnt lgkmcnt(0)
    v_mfma_f32_16x16x32_bf16 v[148:151], v[10:13], v[96:99], v[148:151]
    v_mfma_f32_16x16x32_bf16 v[148:151], v[216:219], v[196:199], v[148:151]
    v_mfma_f32_16x16x32_bf16 v[148:151], v[216:219], v[96:99], v[148:151]
    v_mfma_f32_16x16x32_bf16 v[148:151], v[14:17], v[100:103], v[148:151]
    v_mfma_f32_16x16x32_bf16 v[148:151], v[220:223], v[200:203], v[148:151]
    v_mfma_f32_16x16x32_bf16 v[148:151], v[220:223], v[100:103], v[148:151]
    v_mfma_f32_16x16x32_bf16 v[148:151], v[18:21], v[104:107], v[148:151]
    v_mfma_f32_16x16x32_bf16 v[148:151], v[224:227], v[204:207], v[148:151]
    v_mfma_f32_16x16x32_bf16 v[148:151], v[224:227], v[104:107], v[148:151]
    v_mfma_f32_16x16x32_bf16 v[148:151], v[22:25], v[108:111], v[148:151]
    v_mfma_f32_16x16x32_bf16 v[148:151], v[228:231], v[208:211], v[148:151]
    v_mfma_f32_16x16x32_bf16 v[148:151], v[228:231], v[108:111], v[148:151]
    v_pk_mul_f32 v[48:49], v[184:185], v[192:193] op_sel:[0,0] op_sel_hi:[0,1]
    v_pk_mul_f32 v[50:51], v[192:193], v[192:193] op_sel:[0,0] op_sel_hi:[0,1]
    v_pk_fma_f32 v[186:187], v[184:185], v[192:193], v[48:49] op_sel:[1,1,0] op_sel_hi:[1,0,1] neg_lo:[1,0,0] neg_hi:[0,0,0]
    v_pk_fma_f32 v[188:189], v[192:193], v[192:193], v[50:51] op_sel:[1,1,0] op_sel_hi:[1,0,1] neg_lo:[1,0,0] neg_hi:[0,0,0]
    s_nop 0
    v_pk_mul_f32 v[48:49], v[184:185], v[188:189] op_sel:[0,0] op_sel_hi:[0,1]
    v_pk_mul_f32 v[50:51], v[186:187], v[188:189] op_sel:[0,0] op_sel_hi:[0,1]
    v_pk_fma_f32 v[190:191], v[184:185], v[188:189], v[48:49] op_sel:[1,1,0] op_sel_hi:[1,0,1] neg_lo:[1,0,0] neg_hi:[0,0,0]
    v_pk_fma_f32 v[162:163], v[186:187], v[188:189], v[50:51] op_sel:[1,1,0] op_sel_hi:[1,0,1] neg_lo:[1,0,0] neg_hi:[0,0,0]
    v_mov_b32 v48, v184
    v_mov_b32 v60, v186
    v_mov_b32 v72, v190
    v_mov_b32 v84, v162
    v_mov_b32 v49, v185
    v_mov_b32 v61, v187
    v_mov_b32 v73, v191
    v_mov_b32 v85, v163
    v_add_u32 v58, 8704, v246
    v_add_u32 v70, 9792, v246
    v_add_u32 v82, 10880, v246
    v_add_u32 v94, 11968, v246
    v_pk_mul_f32 v[52:53], v[48:49], v[168:169] op_sel:[0,0] op_sel_hi:[0,1]
    v_pk_mul_f32 v[64:65], v[60:61], v[168:169] op_sel:[0,0] op_sel_hi:[0,1]
    v_pk_mul_f32 v[76:77], v[72:73], v[168:169] op_sel:[0,0] op_sel_hi:[0,1]
    v_pk_mul_f32 v[88:89], v[84:85], v[168:169] op_sel:[0,0] op_sel_hi:[0,1]
    v_pk_fma_f32 v[50:51], v[48:49], v[168:169], v[52:53] op_sel:[1,1,0] op_sel_hi:[1,0,1] neg_lo:[1,0,0] neg_hi:[0,0,0]
    v_pk_fma_f32 v[62:63], v[60:61], v[168:169], v[64:65] op_sel:[1,1,0] op_sel_hi:[1,0,1] neg_lo:[1,0,0] neg_hi:[0,0,0]
    v_pk_fma_f32 v[74:75], v[72:73], v[168:169], v[76:77] op_sel:[1,1,0] op_sel_hi:[1,0,1] neg_lo:[1,0,0] neg_hi:[0,0,0]
    v_pk_fma_f32 v[86:87], v[84:85], v[168:169], v[88:89] op_sel:[1,1,0] op_sel_hi:[1,0,1] neg_lo:[1,0,0] neg_hi:[0,0,0]
    v_cvt_pk_bf16_f32 v56, v48, -v49
    v_cvt_pk_bf16_f32 v68, v60, -v61
    v_cvt_pk_bf16_f32 v80, v72, -v73
    v_cvt_pk_bf16_f32 v92, v84, -v85
    v_lshlrev_b32 v54, 16, v56
    v_lshlrev_b32 v66, 16, v68
    v_lshlrev_b32 v78, 16, v80
    v_lshlrev_b32 v90, 16, v92
    v_and_b32 v55, 0xffff0000, v56
    v_and_b32 v67, 0xffff0000, v68
    v_and_b32 v79, 0xffff0000, v80
    v_and_b32 v91, 0xffff0000, v92
    v_pk_add_f32 v[54:55], v[48:49], v[54:55] neg_lo:[0,1] neg_hi:[1,1]
    v_pk_add_f32 v[66:67], v[60:61], v[66:67] neg_lo:[0,1] neg_hi:[1,1]
    v_pk_add_f32 v[78:79], v[72:73], v[78:79] neg_lo:[0,1] neg_hi:[1,1]
    v_pk_add_f32 v[90:91], v[84:85], v[90:91] neg_lo:[0,1] neg_hi:[1,1]
    v_cvt_pk_bf16_f32 v57, v54, v55
    v_cvt_pk_bf16_f32 v69, v66, v67
    v_cvt_pk_bf16_f32 v81, v78, v79
    v_cvt_pk_bf16_f32 v93, v90, v91
    ds_write2_b32 v58, v56, v57 offset0:0 offset1:64
    ds_write2_b32 v70, v68, v69 offset0:0 offset1:64
    ds_write2_b32 v82, v80, v81 offset0:0 offset1:64
    ds_write2_b32 v94, v92, v93 offset0:0 offset1:64
    v_add_u32 v58, 544, v58
    v_add_u32 v70, 544, v70
    v_add_u32 v82, 544, v82
    v_add_u32 v94, 544, v94
    v_pk_mul_f32 v[52:53], v[50:51], v[168:169] op_sel:[0,0] op_sel_hi:[0,1]
    v_pk_mul_f32 v[64:65], v[62:63], v[168:169] op_sel:[0,0] op_sel_hi:[0,1]
    v_pk_mul_f32 v[76:77], v[74:75], v[168:169] op_sel:[0,0] op_sel_hi:[0,1]
    v_pk_mul_f32 v[88:89], v[86:87], v[168:169] op_sel:[0,0] op_sel_hi:[0,1]
    v_pk_fma_f32 v[48:49], v[50:51], v[168:169], v[52:53] op_sel:[1,1,0] op_sel_hi:[1,0,1] neg_lo:[1,0,0] neg_hi:[0,0,0]
    v_pk_fma_f32 v[60:61], v[62:63], v[168:169], v[64:65] op_sel:[1,1,0] op_sel_hi:[1,0,1] neg_lo:[1,0,0] neg_hi:[0,0,0]
    v_pk_fma_f32 v[72:73], v[74:75], v[168:169], v[76:77] op_sel:[1,1,0] op_sel_hi:[1,0,1] neg_lo:[1,0,0] neg_hi:[0,0,0]
    v_pk_fma_f32 v[84:85], v[86:87], v[168:169], v[88:89] op_sel:[1,1,0] op_sel_hi:[1,0,1] neg_lo:[1,0,0] neg_hi:[0,0,0]
    v_cvt_pk_bf16_f32 v56, v50, -v51
    v_cvt_pk_bf16_f32 v68, v62, -v63
    v_cvt_pk_bf16_f32 v80, v74, -v75
    v_cvt_pk_bf16_f32 v92, v86, -v87
    v_lshlrev_b32 v54, 16, v56
    v_lshlrev_b32 v66, 16, v68
    v_lshlrev_b32 v78, 16, v80
    v_lshlrev_b32 v90, 16, v92
    v_and_b32 v55, 0xffff0000, v56
    v_and_b32 v67, 0xffff0000, v68
    v_and_b32 v79, 0xffff0000, v80
    v_and_b32 v91, 0xffff0000, v92
    v_pk_add_f32 v[54:55], v[50:51], v[54:55] neg_lo:[0,1] neg_hi:[1,1]
    v_pk_add_f32 v[66:67], v[62:63], v[66:67] neg_lo:[0,1] neg_hi:[1,1]
    v_pk_add_f32 v[78:79], v[74:75], v[78:79] neg_lo:[0,1] neg_hi:[1,1]
    v_pk_add_f32 v[90:91], v[86:87], v[90:91] neg_lo:[0,1] neg_hi:[1,1]
    v_cvt_pk_bf16_f32 v57, v54, v55
    v_cvt_pk_bf16_f32 v69, v66, v67
    v_cvt_pk_bf16_f32 v81, v78, v79
    v_cvt_pk_bf16_f32 v93, v90, v91
    ds_write2_b32 v58, v56, v57 offset0:0 offset1:64
    ds_write2_b32 v70, v68, v69 offset0:0 offset1:64
    ds_write2_b32 v82, v80, v81 offset0:0 offset1:64
    ds_write2_b32 v94, v92, v93 offset0:0 offset1:64
    v_add_u32 v58, 544, v58
    v_add_u32 v70, 544, v70
    v_add_u32 v82, 544, v82
    v_add_u32 v94, 544, v94
    v_mov_b32 v48, v178
    v_mov_b32 v49, v179
    v_add_u32 v58, 13056, v246
    v_cvt_pk_bf16_f32 v56, v48, -v49
    v_lshlrev_b32 v54, 16, v56
    v_and_b32 v55, 0xffff0000, v56
    v_pk_add_f32 v[54:55], v[48:49], v[54:55] neg_lo:[0,1] neg_hi:[1,1]
    v_cvt_pk_bf16_f32 v57, v54, v55
    ds_write2_b32 v58, v56, v57 offset0:0 offset1:64
    ds_read_b128 v[216:219], v247 offset:8704
    ds_read_b128 v[10:13], v247 offset:8960
    ds_read_b128 v[220:223], v247 offset:8768
    ds_read_b128 v[14:17], v247 offset:9024
    ds_read_b128 v[224:227], v247 offset:8832
    ds_read_b128 v[18:21], v247 offset:9088
    ds_read_b128 v[228:231], v247 offset:8896
    ds_read_b128 v[22:25], v247 offset:9152
    s_waitcnt lgkmcnt(0)
    v_mfma_f32_16x16x32_bf16 v[152:155], v[10:13], v[96:99], v[152:155]
    v_mfma_f32_16x16x32_bf16 v[152:155], v[216:219], v[196:199], v[152:155]
    v_mfma_f32_16x16x32_bf16 v[152:155], v[216:219], v[96:99], v[152:155]
    v_mfma_f32_16x16x32_bf16 v[152:155], v[14:17], v[100:103], v[152:155]
    v_mfma_f32_16x16x32_bf16 v[152:155], v[220:223], v[200:203], v[152:155]
    v_mfma_f32_16x16x32_bf16 v[152:155], v[220:223], v[100:103], v[152:155]
    v_mfma_f32_16x16x32_bf16 v[152:155], v[18:21], v[104:107], v[152:155]
    v_mfma_f32_16x16x32_bf16 v[152:155], v[224:227], v[204:207], v[152:155]
    v_mfma_f32_16x16x32_bf16 v[152:155], v[224:227], v[104:107], v[152:155]
    v_mfma_f32_16x16x32_bf16 v[152:155], v[22:25], v[108:111], v[152:155]
    v_mfma_f32_16x16x32_bf16 v[152:155], v[228:231], v[208:211], v[152:155]
    v_mfma_f32_16x16x32_bf16 v[152:155], v[228:231], v[108:111], v[152:155]
    v_mov_b32 v30, v112
    v_mov_b32 v31, v113
    v_mov_b32 v32, v114
    v_mov_b32 v33, v115
    s_sub_u32 s97, s97, 1
    s_cmp_lg_u32 s97, 0
    s_nop 13
    s_cbranch_scc1 Lhalf_1
    s_waitcnt lgkmcnt(0)
    v_mov_b32 v120, 20848
    v_mov_b32 v121, 1
    v_cmp_eq_u32 vcc, 0, v1
    s_nop 0
    s_and_saveexec_b64 s[42:43], vcc
    ds_add_u32 v120, v121
    s_mov_b64 exec, s[42:43]
    v_lshrrev_b32 v160, 4, v1
    v_lshlrev_b32 v161, 3, v129
    v_and_b32 v162, 1, v160
    v_lshrrev_b32 v163, 1, v160
    v_cmp_eq_u32 s[8:9], 0, v163
    v_cmp_eq_u32 s[10:11], 2, v160
    v_lshlrev_b32 v168, 2, v162
    v_lshl_add_u32 v168, v163, 7, v168
    v_add_u32 v168, v168, v161
    v_lshl_add_u32 v168, v168, 2, s38
    ds_write_b32 v168, v144 offset:0
    ds_write_b32 v168, v145 offset:4
    ds_write_b32 v168, v146 offset:8
    ds_write_b32 v168, v147 offset:12
    v_lshlrev_b32 v48, 7, v160
    v_lshlrev_b32 v51, 9, v160
    v_lshlrev_b32 v54, 7, v160
    v_lshlrev_b32 v57, 9, v160
    v_lshlrev_b32 v60, 7, v160
    v_lshlrev_b32 v63, 9, v160
    v_lshlrev_b32 v66, 7, v160
    v_lshlrev_b32 v69, 9, v160
    v_add_u32 v48, 258, v48
    v_add_u32 v51, 1032, v51
    v_add_u32 v54, 260, v54
    v_add_u32 v57, 1160, v57
    v_add_u32 v60, 262, v60
    v_add_u32 v63, 1288, v63
    v_add_u32 v66, 264, v66
    v_add_u32 v69, 1416, v69
    v_lshlrev_b32 v49, 8, v160
    v_mov_b32 v52, 4400
    v_lshlrev_b32 v55, 8, v160
    v_mov_b32 v58, 4400
    v_lshlrev_b32 v61, 8, v160
    v_mov_b32 v64, 4400
    v_lshlrev_b32 v67, 8, v160
    v_mov_b32 v70, 4400
    v_add_u32 v49, 4, v49
    v_mov_b32 v53, 256
    v_add_u32 v55, 8, v55
    v_cndmask_b32 v57, v58, v57, s[8:9]
    v_add_u32 v61, 132, v61
    v_cndmask_b32 v63, v64, v63, s[8:9]
    v_add_u32 v67, 136, v67
    v_cndmask_b32 v69, v70, v69, s[8:9]
    v_cndmask_b32 v48, v49, v48, s[8:9]
    v_cndmask_b32 v52, v52, v53, s[10:11]
    v_cndmask_b32 v54, v55, v54, s[8:9]
    v_add_u32 v57, v57, v161
    v_cndmask_b32 v60, v61, v60, s[8:9]
    v_add_u32 v63, v63, v161
    v_cndmask_b32 v66, v67, v66, s[8:9]
    v_add_u32 v69, v69, v161
    v_add_u32 v48, v48, v161
    v_cndmask_b32 v51, v52, v51, s[8:9]
    v_add_u32 v54, v54, v161
    v_lshl_add_u32 v57, v57, 2, s38
    v_add_u32 v60, v60, v161
    v_lshl_add_u32 v63, v63, 2, s38
    v_add_u32 v66, v66, v161
    v_lshl_add_u32 v69, v69, 2, s38
    v_lshl_add_u32 v48, v48, 2, s38
    v_add_u32 v51, v51, v161
    v_lshl_add_u32 v54, v54, 2, s38
    ds_write_b32 v57, v153
    v_lshl_add_u32 v60, v60, 2, s38
    ds_write_b32 v63, v154
    v_lshl_add_u32 v66, v66, 2, s38
    ds_write_b32 v69, v155
    ds_write_b32 v48, v148
    v_lshl_add_u32 v51, v51, 2, s38
    ds_write_b32 v54, v149
    ds_write_b32 v60, v150
    ds_write_b32 v66, v151
    ds_write_b32 v51, v152
    v_lshlrev_b32 v171, 3, v1
    v_mov_b32 v172, v26
    s_mov_b32 s96, 4
Lg_5:
    v_add_u32 v196, 0, v171
    v_add_u32 v197, 1, v171
    v_add_u32 v198, 2, v171
    v_add_u32 v199, 3, v171
    v_add_u32 v200, 4, v171
    v_add_u32 v201, 5, v171
    v_add_u32 v202, 6, v171
    v_add_u32 v203, 7, v171
    v_cvt_f32_u32 v196, v196
    v_cvt_f32_u32 v197, v197
    v_cvt_f32_u32 v198, v198
    v_cvt_f32_u32 v199, v199
    v_cvt_f32_u32 v200, v200
    v_cvt_f32_u32 v201, v201
    v_cvt_f32_u32 v202, v202
    v_cvt_f32_u32 v203, v203
    v_cvt_pk_bf16_f32 v196, v196, v196
    v_cvt_pk_bf16_f32 v197, v197, v197
    v_cvt_pk_bf16_f32 v198, v198, v198
    v_cvt_pk_bf16_f32 v199, v199, v199
    v_cvt_pk_bf16_f32 v200, v200, v200
    v_cvt_pk_bf16_f32 v201, v201, v201
    v_cvt_pk_bf16_f32 v202, v202, v202
    v_cvt_pk_bf16_f32 v203, v203, v203
    v_lshlrev_b32 v196, 16, v196
    v_lshlrev_b32 v197, 16, v197
    v_lshlrev_b32 v198, 16, v198
    v_lshlrev_b32 v199, 16, v199
    v_lshlrev_b32 v200, 16, v200
    v_lshlrev_b32 v201, 16, v201
    v_lshlrev_b32 v202, 16, v202
    v_lshlrev_b32 v203, 16, v203
    v_cvt_u32_f32 v196, v196
    v_cvt_u32_f32 v197, v197
    v_cvt_u32_f32 v198, v198
    v_cvt_u32_f32 v199, v199
    v_cvt_u32_f32 v200, v200
    v_cvt_u32_f32 v201, v201
    v_cvt_u32_f32 v202, v202
    v_cvt_u32_f32 v203, v203
    v_lshl_add_u32 v196, v196, 2, s38
    v_lshl_add_u32 v197, v197, 2, s38
    v_lshl_add_u32 v198, v198, 2, s38
    v_lshl_add_u32 v199, v199, 2, s38
    v_lshl_add_u32 v200, v200, 2, s38
    v_lshl_add_u32 v201, v201, 2, s38
    v_lshl_add_u32 v202, v202, 2, s38
    v_lshl_add_u32 v203, v203, 2, s38
    ds_read_b32 v176, v196
    ds_read_b32 v177, v197
    ds_read_b32 v178, v198
    ds_read_b32 v179, v199
    ds_read_b32 v180, v200
    ds_read_b32 v181, v201
    ds_read_b32 v182, v202
    ds_read_b32 v183, v203
    v_add_u32 v171, 512, v171
    s_waitcnt lgkmcnt(0)
    v_cvt_pk_bf16_f32 v184, v176, v177
    v_cvt_pk_bf16_f32 v185, v178, v179
    v_cvt_pk_bf16_f32 v186, v180, v181
    v_cvt_pk_bf16_f32 v187, v182, v183
    v_lshlrev_b32 v204, 16, v184
    v_lshlrev_b32 v206, 16, v185
    v_lshlrev_b32 v208, 16, v186
    v_lshlrev_b32 v210, 16, v187
    v_and_b32 v205, 0xffff0000, v184
    v_and_b32 v207, 0xffff0000, v185
    v_and_b32 v209, 0xffff0000, v186
    v_and_b32 v211, 0xffff0000, v187
    v_pk_add_f32 v[204:205], v[176:177], v[204:205] neg_lo:[0,1] neg_hi:[0,1]
    v_pk_add_f32 v[206:207], v[178:179], v[206:207] neg_lo:[0,1] neg_hi:[0,1]
    v_pk_add_f32 v[208:209], v[180:181], v[208:209] neg_lo:[0,1] neg_hi:[0,1]
    v_pk_add_f32 v[210:211], v[182:183], v[210:211] neg_lo:[0,1] neg_hi:[0,1]
    v_cvt_pk_bf16_f32 v188, v204, v205
    v_cvt_pk_bf16_f32 v189, v206, v207
    v_cvt_pk_bf16_f32 v190, v208, v209
    v_cvt_pk_bf16_f32 v191, v210, v211
    ds_write_b128 v172, v[184:187]
    ds_write_b128 v172, v[188:191] offset:4096
    v_add_u32 v172, 1024, v172
    s_sub_u32 s96, s96, 1
    s_cmp_lg_u32 s96, 0
    s_cbranch_scc1 Lg_5
    v_lshlrev_b32 v120, 2, v1
    v_add_u32 v120, s39, v120
    v_mov_b32 v121, 0
    v_cmp_gt_u32 vcc, 16, v1
    s_nop 0
    s_and_saveexec_b64 s[42:43], vcc
    ds_write_b32 v120, v121
    s_mov_b64 exec, s[42:43]
    v_mov_b32 v122, 20840
    s_nop 4
Lxa_6:
    ds_read_b32 v120, v122
    s_waitcnt lgkmcnt(0)
    v_readfirstlane_b32 s96, v120
    s_nop 0
    s_cmp_lt_u32 s96, 4
    s_nop 2
    s_cbranch_scc1 Lxa_6
    v_mov_b32 v144, 0
    v_mov_b32 v145, 0
    v_mov_b32 v146, 0
    v_mov_b32 v147, 0
    v_mov_b32 v148, 0
    v_mov_b32 v149, 0
    v_mov_b32 v150, 0
    v_mov_b32 v151, 0
    v_mov_b32 v152, 0
    v_mov_b32 v153, 0
    v_mov_b32 v154, 0
    v_mov_b32 v155, 0
    v_mov_b32 v156, 0
    v_mov_b32 v157, 0
    v_mov_b32 v158, 0
    v_mov_b32 v159, 0
    v_mov_b32 v160, 0
    v_mov_b32 v161, 0
    v_mov_b32 v162, 0
    v_mov_b32 v163, 0
    v_mov_b32 v164, 0
    v_mov_b32 v165, 0
    v_mov_b32 v166, 0
    v_mov_b32 v167, 0
    v_mov_b32 v168, 0
    v_mov_b32 v169, 0
    v_mov_b32 v170, 0
    v_mov_b32 v171, 0
    v_mov_b32 v172, 0
    v_mov_b32 v173, 0
    v_mov_b32 v174, 0
    v_mov_b32 v175, 0
    s_waitcnt lgkmcnt(0)
    v_add_u32 v133, 0, v138
    v_mov_b32 v134, v139
    v_mov_b32 v135, v1
    s_mov_b32 s96, 5
Lcp_7:
    ds_read_b64 v[120:121], v133
    ds_read_b64 v[122:123], v133 offset:8
    v_cmp_gt_u32 vcc, 263, v135
    v_subrev_u32 v133, 512, v133
    v_add_u32 v135, 64, v135
    s_waitcnt lgkmcnt(0)
    v_alignbit_b32 v240, v123, v123, 16
    v_alignbit_b32 v241, v122, v122, 16
    v_bfi_b32 v242, v140, v123, v122
    v_bfi_b32 v243, v140, v122, v121
    v_mov_b32 v244, v241
    v_alignbit_b32 v245, v121, v121, 16
    v_mov_b32 v246, v243
    v_bfi_b32 v247, v140, v121, v120
    s_and_saveexec_b64 s[42:43], vcc
    ds_write_b128 v134, v[240:243]
    ds_write_b128 v134, v[244:247] offset:16
    s_mov_b64 exec, s[42:43]
    v_add_u32 v134, 2048, v134
    s_sub_u32 s96, s96, 1
    s_cmp_lg_u32 s96, 0
    s_cbranch_scc1 Lcp_7
    s_waitcnt lgkmcnt(0)
    v_mov_b32 v8, v130
    ds_read_b64 v[176:177], v8 offset:4480
    ds_read_b64 v[178:179], v8 offset:4512
    ds_read_b64 v[180:181], v8 offset:4352
    ds_read_b64 v[182:183], v8 offset:4384
    ds_read_b64 v[184:185], v8 offset:384
    ds_read_b64 v[186:187], v8 offset:416
    ds_read_b64 v[188:189], v8 offset:256
    ds_read_b64 v[190:191], v8 offset:288
    ds_read_b128 v[208:211], v132 offset:0
    ds_read_b128 v[212:215], v132 offset:1024
    ds_read_b128 v[216:219], v132 offset:2048
    ds_read_b128 v[220:223], v132 offset:3072
    ds_read_b128 v[224:227], v132 offset:4096
    ds_read_b128 v[228:231], v132 offset:5120
    ds_read_b128 v[232:235], v132 offset:6144
    ds_read_b128 v[236:239], v132 offset:7168
    s_mov_b32 s96, 8
Lcv_8:
    s_waitcnt lgkmcnt(0)
    ds_read_b64 v[192:193], v8 offset:4224
    ds_read_b64 v[194:195], v8 offset:4256
    ds_read_b64 v[196:197], v8 offset:4096
    ds_read_b64 v[198:199], v8 offset:4128
    ds_read_b64 v[200:201], v8 offset:128
    ds_read_b64 v[202:203], v8 offset:160
    ds_read_b64 v[204:205], v8 offset:0
    ds_read_b64 v[206:207], v8 offset:32
    v_mfma_f32_16x16x32_bf16 v[144:147], v[176:179], v[208:211], v[144:147]
    v_mov_b32_dpp v48, v208 row_shr:1 row_mask:0xf bank_mask:0xf bound_ctrl:0
    v_mov_b32_dpp v49, v209 row_shr:1 row_mask:0xf bank_mask:0xf bound_ctrl:0
    v_mfma_f32_16x16x32_bf16 v[148:151], v[180:183], v[208:211], v[148:151]
    v_mov_b32_dpp v50, v210 row_shr:1 row_mask:0xf bank_mask:0xf bound_ctrl:0
    v_mov_b32_dpp v51, v211 row_shr:1 row_mask:0xf bank_mask:0xf bound_ctrl:0
    v_mfma_f32_16x16x32_bf16 v[144:147], v[176:179], v[224:227], v[144:147]
    v_mov_b32_dpp v52, v208 row_ror:1 row_mask:0xf bank_mask:0xf
    v_mov_b32_dpp v53, v209 row_ror:1 row_mask:0xf bank_mask:0xf
    v_mfma_f32_16x16x32_bf16 v[148:151], v[180:183], v[224:227], v[148:151]
    v_mov_b32_dpp v54, v210 row_ror:1 row_mask:0xf bank_mask:0xf
    v_mov_b32_dpp v55, v211 row_ror:1 row_mask:0xf bank_mask:0xf
    v_mfma_f32_16x16x32_bf16 v[152:155], v[176:179], v[212:215], v[152:155]
    v_mov_b32_dpp v52, v212 row_shr:1 row_mask:0xf bank_mask:0xf
    v_mov_b32_dpp v53, v213 row_shr:1 row_mask:0xf bank_mask:0xf
    v_mfma_f32_16x16x32_bf16 v[156:159], v[180:183], v[212:215], v[156:159]
    v_mov_b32_dpp v54, v214 row_shr:1 row_mask:0xf bank_mask:0xf
    v_mov_b32_dpp v55, v215 row_shr:1 row_mask:0xf bank_mask:0xf
    v_mfma_f32_16x16x32_bf16 v[152:155], v[176:179], v[228:231], v[152:155]
    v_mov_b32_dpp v56, v212 row_ror:1 row_mask:0xf bank_mask:0xf
    v_mov_b32_dpp v57, v213 row_ror:1 row_mask:0xf bank_mask:0xf
    v_mfma_f32_16x16x32_bf16 v[156:159], v[180:183], v[228:231], v[156:159]
    v_mov_b32_dpp v58, v214 row_ror:1 row_mask:0xf bank_mask:0xf
    v_mov_b32_dpp v59, v215 row_ror:1 row_mask:0xf bank_mask:0xf
    v_mfma_f32_16x16x32_bf16 v[160:163], v[176:179], v[216:219], v[160:163]
    v_mov_b32_dpp v56, v216 row_shr:1 row_mask:0xf bank_mask:0xf
    v_mov_b32_dpp v57, v217 row_shr:1 row_mask:0xf bank_mask:0xf
    v_mfma_f32_16x16x32_bf16 v[164:167], v[180:183], v[216:219], v[164:167]
    v_mov_b32_dpp v58, v218 row_shr:1 row_mask:0xf bank_mask:0xf
    v_mov_b32_dpp v59, v219 row_shr:1 row_mask:0xf bank_mask:0xf
    v_mfma_f32_16x16x32_bf16 v[160:163], v[176:179], v[232:235], v[160:163]
    v_mov_b32_dpp v60, v216 row_ror:1 row_mask:0xf bank_mask:0xf
    v_mov_b32_dpp v61, v217 row_ror:1 row_mask:0xf bank_mask:0xf
    v_mfma_f32_16x16x32_bf16 v[164:167], v[180:183], v[232:235], v[164:167]
    v_mov_b32_dpp v62, v218 row_ror:1 row_mask:0xf bank_mask:0xf
    v_mov_b32_dpp v63, v219 row_ror:1 row_mask:0xf bank_mask:0xf
    v_mfma_f32_16x16x32_bf16 v[168:171], v[176:179], v[220:223], v[168:171]
    v_mov_b32_dpp v60, v220 row_shr:1 row_mask:0xf bank_mask:0xf
    v_mov_b32_dpp v61, v221 row_shr:1 row_mask:0xf bank_mask:0xf
    v_mfma_f32_16x16x32_bf16 v[172:175], v[180:183], v[220:223], v[172:175]
    v_mov_b32_dpp v62, v222 row_shr:1 row_mask:0xf bank_mask:0xf
    v_mov_b32_dpp v63, v223 row_shr:1 row_mask:0xf bank_mask:0xf
    v_mfma_f32_16x16x32_bf16 v[168:171], v[176:179], v[236:239], v[168:171]
    v_mov_b32_dpp v64, v224 row_shr:1 row_mask:0xf bank_mask:0xf bound_ctrl:0
    v_mov_b32_dpp v65, v225 row_shr:1 row_mask:0xf bank_mask:0xf bound_ctrl:0
    v_mfma_f32_16x16x32_bf16 v[172:175], v[180:183], v[236:239], v[172:175]
    v_mov_b32_dpp v66, v226 row_shr:1 row_mask:0xf bank_mask:0xf bound_ctrl:0
    v_mov_b32_dpp v67, v227 row_shr:1 row_mask:0xf bank_mask:0xf bound_ctrl:0
    v_mfma_f32_16x16x32_bf16 v[152:155], v[184:187], v[208:211], v[152:155]
    v_mov_b32_dpp v68, v224 row_ror:1 row_mask:0xf bank_mask:0xf
    v_mov_b32_dpp v69, v225 row_ror:1 row_mask:0xf bank_mask:0xf
    v_mfma_f32_16x16x32_bf16 v[156:159], v[188:191], v[208:211], v[156:159]
    v_mov_b32_dpp v70, v226 row_ror:1 row_mask:0xf bank_mask:0xf
    v_mov_b32_dpp v71, v227 row_ror:1 row_mask:0xf bank_mask:0xf
    v_mfma_f32_16x16x32_bf16 v[152:155], v[184:187], v[224:227], v[152:155]
    v_mov_b32_dpp v68, v228 row_shr:1 row_mask:0xf bank_mask:0xf
    v_mov_b32_dpp v69, v229 row_shr:1 row_mask:0xf bank_mask:0xf
    v_mfma_f32_16x16x32_bf16 v[156:159], v[188:191], v[224:227], v[156:159]
    v_mov_b32_dpp v70, v230 row_shr:1 row_mask:0xf bank_mask:0xf
    v_mov_b32_dpp v71, v231 row_shr:1 row_mask:0xf bank_mask:0xf
    v_mfma_f32_16x16x32_bf16 v[160:163], v[184:187], v[212:215], v[160:163]
    v_mov_b32_dpp v72, v228 row_ror:1 row_mask:0xf bank_mask:0xf
    v_mov_b32_dpp v73, v229 row_ror:1 row_mask:0xf bank_mask:0xf
    v_mfma_f32_16x16x32_bf16 v[164:167], v[188:191], v[212:215], v[164:167]
    v_mov_b32_dpp v74, v230 row_ror:1 row_mask:0xf bank_mask:0xf
    v_mov_b32_dpp v75, v231 row_ror:1 row_mask:0xf bank_mask:0xf
    v_mfma_f32_16x16x32_bf16 v[160:163], v[184:187], v[228:231], v[160:163]
    v_mov_b32_dpp v72, v232 row_shr:1 row_mask:0xf bank_mask:0xf
    v_mov_b32_dpp v73, v233 row_shr:1 row_mask:0xf bank_mask:0xf
    v_mfma_f32_16x16x32_bf16 v[164:167], v[188:191], v[228:231], v[164:167]
    v_mov_b32_dpp v74, v234 row_shr:1 row_mask:0xf bank_mask:0xf
    v_mov_b32_dpp v75, v235 row_shr:1 row_mask:0xf bank_mask:0xf
    v_mfma_f32_16x16x32_bf16 v[168:171], v[184:187], v[216:219], v[168:171]
    v_mov_b32_dpp v76, v232 row_ror:1 row_mask:0xf bank_mask:0xf
    v_mov_b32_dpp v77, v233 row_ror:1 row_mask:0xf bank_mask:0xf
    v_mfma_f32_16x16x32_bf16 v[172:175], v[188:191], v[216:219], v[172:175]
    v_mov_b32_dpp v78, v234 row_ror:1 row_mask:0xf bank_mask:0xf
    v_mov_b32_dpp v79, v235 row_ror:1 row_mask:0xf bank_mask:0xf
    v_mfma_f32_16x16x32_bf16 v[168:171], v[184:187], v[232:235], v[168:171]
    v_mov_b32_dpp v76, v236 row_shr:1 row_mask:0xf bank_mask:0xf
    v_mov_b32_dpp v77, v237 row_shr:1 row_mask:0xf bank_mask:0xf
    v_mfma_f32_16x16x32_bf16 v[172:175], v[188:191], v[232:235], v[172:175]
    v_mov_b32_dpp v78, v238 row_shr:1 row_mask:0xf bank_mask:0xf
    v_mov_b32_dpp v79, v239 row_shr:1 row_mask:0xf bank_mask:0xf
    v_subrev_u32 v8, 512, v8
    s_waitcnt lgkmcnt(0)
    ds_read_b64 v[176:177], v8 offset:4480
    ds_read_b64 v[178:179], v8 offset:4512
    ds_read_b64 v[180:181], v8 offset:4352
    ds_read_b64 v[182:183], v8 offset:4384
    ds_read_b64 v[184:185], v8 offset:384
    ds_read_b64 v[186:187], v8 offset:416
    ds_read_b64 v[188:189], v8 offset:256
    ds_read_b64 v[190:191], v8 offset:288
    v_mfma_f32_16x16x32_bf16 v[144:147], v[192:195], v[48:51], v[144:147]
    v_mov_b32_dpp v208, v48 row_shr:1 row_mask:0xf bank_mask:0xf bound_ctrl:0
    v_mov_b32_dpp v209, v49 row_shr:1 row_mask:0xf bank_mask:0xf bound_ctrl:0
    v_mfma_f32_16x16x32_bf16 v[148:151], v[196:199], v[48:51], v[148:151]
    v_mov_b32_dpp v210, v50 row_shr:1 row_mask:0xf bank_mask:0xf bound_ctrl:0
    v_mov_b32_dpp v211, v51 row_shr:1 row_mask:0xf bank_mask:0xf bound_ctrl:0
    v_mfma_f32_16x16x32_bf16 v[144:147], v[192:195], v[64:67], v[144:147]
    v_mov_b32_dpp v212, v48 row_ror:1 row_mask:0xf bank_mask:0xf
    v_mov_b32_dpp v213, v49 row_ror:1 row_mask:0xf bank_mask:0xf
    v_mfma_f32_16x16x32_bf16 v[148:151], v[196:199], v[64:67], v[148:151]
    v_mov_b32_dpp v214, v50 row_ror:1 row_mask:0xf bank_mask:0xf
    v_mov_b32_dpp v215, v51 row_ror:1 row_mask:0xf bank_mask:0xf
    v_mfma_f32_16x16x32_bf16 v[152:155], v[192:195], v[52:55], v[152:155]
    v_mov_b32_dpp v212, v52 row_shr:1 row_mask:0xf bank_mask:0xf
    v_mov_b32_dpp v213, v53 row_shr:1 row_mask:0xf bank_mask:0xf
    v_mfma_f32_16x16x32_bf16 v[156:159], v[196:199], v[52:55], v[156:159]
    v_mov_b32_dpp v214, v54 row_shr:1 row_mask:0xf bank_mask:0xf
    v_mov_b32_dpp v215, v55 row_shr:1 row_mask:0xf bank_mask:0xf
    v_mfma_f32_16x16x32_bf16 v[152:155], v[192:195], v[68:71], v[152:155]
    v_mov_b32_dpp v216, v52 row_ror:1 row_mask:0xf bank_mask:0xf
    v_mov_b32_dpp v217, v53 row_ror:1 row_mask:0xf bank_mask:0xf
    v_mfma_f32_16x16x32_bf16 v[156:159], v[196:199], v[68:71], v[156:159]
    v_mov_b32_dpp v218, v54 row_ror:1 row_mask:0xf bank_mask:0xf
    v_mov_b32_dpp v219, v55 row_ror:1 row_mask:0xf bank_mask:0xf
    v_mfma_f32_16x16x32_bf16 v[160:163], v[192:195], v[56:59], v[160:163]
    v_mov_b32_dpp v216, v56 row_shr:1 row_mask:0xf bank_mask:0xf
    v_mov_b32_dpp v217, v57 row_shr:1 row_mask:0xf bank_mask:0xf
    v_mfma_f32_16x16x32_bf16 v[164:167], v[196:199], v[56:59], v[164:167]
    v_mov_b32_dpp v218, v58 row_shr:1 row_mask:0xf bank_mask:0xf
    v_mov_b32_dpp v219, v59 row_shr:1 row_mask:0xf bank_mask:0xf
    v_mfma_f32_16x16x32_bf16 v[160:163], v[192:195], v[72:75], v[160:163]
    v_mov_b32_dpp v220, v56 row_ror:1 row_mask:0xf bank_mask:0xf
    v_mov_b32_dpp v221, v57 row_ror:1 row_mask:0xf bank_mask:0xf
    v_mfma_f32_16x16x32_bf16 v[164:167], v[196:199], v[72:75], v[164:167]
    v_mov_b32_dpp v222, v58 row_ror:1 row_mask:0xf bank_mask:0xf
    v_mov_b32_dpp v223, v59 row_ror:1 row_mask:0xf bank_mask:0xf
    v_mfma_f32_16x16x32_bf16 v[168:171], v[192:195], v[60:63], v[168:171]
    v_mov_b32_dpp v220, v60 row_shr:1 row_mask:0xf bank_mask:0xf
    v_mov_b32_dpp v221, v61 row_shr:1 row_mask:0xf bank_mask:0xf
    v_mfma_f32_16x16x32_bf16 v[172:175], v[196:199], v[60:63], v[172:175]
    v_mov_b32_dpp v222, v62 row_shr:1 row_mask:0xf bank_mask:0xf
    v_mov_b32_dpp v223, v63 row_shr:1 row_mask:0xf bank_mask:0xf
    v_mfma_f32_16x16x32_bf16 v[168:171], v[192:195], v[76:79], v[168:171]
    v_mov_b32_dpp v224, v64 row_shr:1 row_mask:0xf bank_mask:0xf bound_ctrl:0
    v_mov_b32_dpp v225, v65 row_shr:1 row_mask:0xf bank_mask:0xf bound_ctrl:0
    v_mfma_f32_16x16x32_bf16 v[172:175], v[196:199], v[76:79], v[172:175]
    v_mov_b32_dpp v226, v66 row_shr:1 row_mask:0xf bank_mask:0xf bound_ctrl:0
    v_mov_b32_dpp v227, v67 row_shr:1 row_mask:0xf bank_mask:0xf bound_ctrl:0
    v_mfma_f32_16x16x32_bf16 v[152:155], v[200:203], v[48:51], v[152:155]
    v_mov_b32_dpp v228, v64 row_ror:1 row_mask:0xf bank_mask:0xf
    v_mov_b32_dpp v229, v65 row_ror:1 row_mask:0xf bank_mask:0xf
    v_mfma_f32_16x16x32_bf16 v[156:159], v[204:207], v[48:51], v[156:159]
    v_mov_b32_dpp v230, v66 row_ror:1 row_mask:0xf bank_mask:0xf
    v_mov_b32_dpp v231, v67 row_ror:1 row_mask:0xf bank_mask:0xf
    v_mfma_f32_16x16x32_bf16 v[152:155], v[200:203], v[64:67], v[152:155]
    v_mov_b32_dpp v228, v68 row_shr:1 row_mask:0xf bank_mask:0xf
    v_mov_b32_dpp v229, v69 row_shr:1 row_mask:0xf bank_mask:0xf
    v_mfma_f32_16x16x32_bf16 v[156:159], v[204:207], v[64:67], v[156:159]
    v_mov_b32_dpp v230, v70 row_shr:1 row_mask:0xf bank_mask:0xf
    v_mov_b32_dpp v231, v71 row_shr:1 row_mask:0xf bank_mask:0xf
    v_mfma_f32_16x16x32_bf16 v[160:163], v[200:203], v[52:55], v[160:163]
    v_mov_b32_dpp v232, v68 row_ror:1 row_mask:0xf bank_mask:0xf
    v_mov_b32_dpp v233, v69 row_ror:1 row_mask:0xf bank_mask:0xf
    v_mfma_f32_16x16x32_bf16 v[164:167], v[204:207], v[52:55], v[164:167]
    v_mov_b32_dpp v234, v70 row_ror:1 row_mask:0xf bank_mask:0xf
    v_mov_b32_dpp v235, v71 row_ror:1 row_mask:0xf bank_mask:0xf
    v_mfma_f32_16x16x32_bf16 v[160:163], v[200:203], v[68:71], v[160:163]
    v_mov_b32_dpp v232, v72 row_shr:1 row_mask:0xf bank_mask:0xf
    v_mov_b32_dpp v233, v73 row_shr:1 row_mask:0xf bank_mask:0xf
    v_mfma_f32_16x16x32_bf16 v[164:167], v[204:207], v[68:71], v[164:167]
    v_mov_b32_dpp v234, v74 row_shr:1 row_mask:0xf bank_mask:0xf
    v_mov_b32_dpp v235, v75 row_shr:1 row_mask:0xf bank_mask:0xf
    v_mfma_f32_16x16x32_bf16 v[168:171], v[200:203], v[56:59], v[168:171]
    v_mov_b32_dpp v236, v72 row_ror:1 row_mask:0xf bank_mask:0xf
    v_mov_b32_dpp v237, v73 row_ror:1 row_mask:0xf bank_mask:0xf
    v_mfma_f32_16x16x32_bf16 v[172:175], v[204:207], v[56:59], v[172:175]
    v_mov_b32_dpp v238, v74 row_ror:1 row_mask:0xf bank_mask:0xf
    v_mov_b32_dpp v239, v75 row_ror:1 row_mask:0xf bank_mask:0xf
    v_mfma_f32_16x16x32_bf16 v[168:171], v[200:203], v[72:75], v[168:171]
    v_mov_b32_dpp v236, v76 row_shr:1 row_mask:0xf bank_mask:0xf
    v_mov_b32_dpp v237, v77 row_shr:1 row_mask:0xf bank_mask:0xf
    v_mfma_f32_16x16x32_bf16 v[172:175], v[204:207], v[72:75], v[172:175]
    v_mov_b32_dpp v238, v78 row_shr:1 row_mask:0xf bank_mask:0xf
    v_mov_b32_dpp v239, v79 row_shr:1 row_mask:0xf bank_mask:0xf
    s_sub_u32 s96, s96, 1
    s_cmp_lg_u32 s96, 0
    s_cbranch_scc1 Lcv_8
    s_waitcnt lgkmcnt(0)
    v_add_u32 v133, 2048, v138
    v_mov_b32 v134, v139
    v_mov_b32 v135, v1
    s_mov_b32 s96, 5
Lcp_9:
    ds_read_b64 v[120:121], v133
    ds_read_b64 v[122:123], v133 offset:8
    v_cmp_gt_u32 vcc, 263, v135
    v_subrev_u32 v133, 512, v133
    v_add_u32 v135, 64, v135
    s_waitcnt lgkmcnt(0)
    v_alignbit_b32 v240, v123, v123, 16
    v_alignbit_b32 v241, v122, v122, 16
    v_bfi_b32 v242, v140, v123, v122
    v_bfi_b32 v243, v140, v122, v121
    v_mov_b32 v244, v241
    v_alignbit_b32 v245, v121, v121, 16
    v_mov_b32 v246, v243
    v_bfi_b32 v247, v140, v121, v120
    s_and_saveexec_b64 s[42:43], vcc
    ds_write_b128 v134, v[240:243]
    ds_write_b128 v134, v[244:247] offset:16
    s_mov_b64 exec, s[42:43]
    v_add_u32 v134, 2048, v134
    s_sub_u32 s96, s96, 1
    s_cmp_lg_u32 s96, 0
    s_cbranch_scc1 Lcp_9
    s_waitcnt lgkmcnt(0)
    v_mov_b32 v8, v130
    ds_read_b64 v[176:177], v8 offset:4480
    ds_read_b64 v[178:179], v8 offset:4512
    ds_read_b64 v[180:181], v8 offset:4352
    ds_read_b64 v[182:183], v8 offset:4384
    ds_read_b64 v[184:185], v8 offset:384
    ds_read_b64 v[186:187], v8 offset:416
    ds_read_b64 v[188:189], v8 offset:256
    ds_read_b64 v[190:191], v8 offset:288
    ds_read_b128 v[208:211], v132 offset:0
    ds_read_b128 v[212:215], v132 offset:1024
    ds_read_b128 v[224:227], v132 offset:4096
    ds_read_b128 v[228:231], v132 offset:5120
    s_mov_b32 s96, 8
Lcv_10:
    s_waitcnt lgkmcnt(0)
    ds_read_b64 v[192:193], v8 offset:4224
    ds_read_b64 v[194:195], v8 offset:4256
    ds_read_b64 v[196:197], v8 offset:4096
    ds_read_b64 v[198:199], v8 offset:4128
    ds_read_b64 v[200:201], v8 offset:128
    ds_read_b64 v[202:203], v8 offset:160
    ds_read_b64 v[204:205], v8 offset:0
    ds_read_b64 v[206:207], v8 offset:32
    v_mfma_f32_16x16x32_bf16 v[160:163], v[176:179], v[208:211], v[160:163]
    v_mov_b32_dpp v48, v208 row_shr:1 row_mask:0xf bank_mask:0xf bound_ctrl:0
    v_mov_b32_dpp v49, v209 row_shr:1 row_mask:0xf bank_mask:0xf bound_ctrl:0
    v_mfma_f32_16x16x32_bf16 v[164:167], v[180:183], v[208:211], v[164:167]
    v_mov_b32_dpp v50, v210 row_shr:1 row_mask:0xf bank_mask:0xf bound_ctrl:0
    v_mov_b32_dpp v51, v211 row_shr:1 row_mask:0xf bank_mask:0xf bound_ctrl:0
    v_mfma_f32_16x16x32_bf16 v[160:163], v[176:179], v[224:227], v[160:163]
    v_mov_b32_dpp v52, v208 row_ror:1 row_mask:0xf bank_mask:0xf
    v_mov_b32_dpp v53, v209 row_ror:1 row_mask:0xf bank_mask:0xf
    v_mfma_f32_16x16x32_bf16 v[164:167], v[180:183], v[224:227], v[164:167]
    v_mov_b32_dpp v54, v210 row_ror:1 row_mask:0xf bank_mask:0xf
    v_mov_b32_dpp v55, v211 row_ror:1 row_mask:0xf bank_mask:0xf
    v_mfma_f32_16x16x32_bf16 v[168:171], v[176:179], v[212:215], v[168:171]
    v_mov_b32_dpp v52, v212 row_shr:1 row_mask:0xf bank_mask:0xf
    v_mov_b32_dpp v53, v213 row_shr:1 row_mask:0xf bank_mask:0xf
    v_mfma_f32_16x16x32_bf16 v[172:175], v[180:183], v[212:215], v[172:175]
    v_mov_b32_dpp v54, v214 row_shr:1 row_mask:0xf bank_mask:0xf
    v_mov_b32_dpp v55, v215 row_shr:1 row_mask:0xf bank_mask:0xf
    v_mfma_f32_16x16x32_bf16 v[168:171], v[176:179], v[228:231], v[168:171]
    v_mov_b32_dpp v64, v224 row_shr:1 row_mask:0xf bank_mask:0xf bound_ctrl:0
    v_mov_b32_dpp v65, v225 row_shr:1 row_mask:0xf bank_mask:0xf bound_ctrl:0
    v_mfma_f32_16x16x32_bf16 v[172:175], v[180:183], v[228:231], v[172:175]
    v_mov_b32_dpp v66, v226 row_shr:1 row_mask:0xf bank_mask:0xf bound_ctrl:0
    v_mov_b32_dpp v67, v227 row_shr:1 row_mask:0xf bank_mask:0xf bound_ctrl:0
    v_mfma_f32_16x16x32_bf16 v[168:171], v[184:187], v[208:211], v[168:171]
    v_mov_b32_dpp v68, v224 row_ror:1 row_mask:0xf bank_mask:0xf
    v_mov_b32_dpp v69, v225 row_ror:1 row_mask:0xf bank_mask:0xf
    v_mfma_f32_16x16x32_bf16 v[172:175], v[188:191], v[208:211], v[172:175]
    v_mov_b32_dpp v70, v226 row_ror:1 row_mask:0xf bank_mask:0xf
    v_mov_b32_dpp v71, v227 row_ror:1 row_mask:0xf bank_mask:0xf
    v_mfma_f32_16x16x32_bf16 v[168:171], v[184:187], v[224:227], v[168:171]
    v_mov_b32_dpp v68, v228 row_shr:1 row_mask:0xf bank_mask:0xf
    v_mov_b32_dpp v69, v229 row_shr:1 row_mask:0xf bank_mask:0xf
    v_mfma_f32_16x16x32_bf16 v[172:175], v[188:191], v[224:227], v[172:175]
    v_mov_b32_dpp v70, v230 row_shr:1 row_mask:0xf bank_mask:0xf
    v_mov_b32_dpp v71, v231 row_shr:1 row_mask:0xf bank_mask:0xf
    v_subrev_u32 v8, 512, v8
    s_waitcnt lgkmcnt(0)
    ds_read_b64 v[176:177], v8 offset:4480
    ds_read_b64 v[178:179], v8 offset:4512
    ds_read_b64 v[180:181], v8 offset:4352
    ds_read_b64 v[182:183], v8 offset:4384
    ds_read_b64 v[184:185], v8 offset:384
    ds_read_b64 v[186:187], v8 offset:416
    ds_read_b64 v[188:189], v8 offset:256
    ds_read_b64 v[190:191], v8 offset:288
    v_mfma_f32_16x16x32_bf16 v[160:163], v[192:195], v[48:51], v[160:163]
    v_mov_b32_dpp v208, v48 row_shr:1 row_mask:0xf bank_mask:0xf bound_ctrl:0
    v_mov_b32_dpp v209, v49 row_shr:1 row_mask:0xf bank_mask:0xf bound_ctrl:0
    v_mfma_f32_16x16x32_bf16 v[164:167], v[196:199], v[48:51], v[164:167]
    v_mov_b32_dpp v210, v50 row_shr:1 row_mask:0xf bank_mask:0xf bound_ctrl:0
    v_mov_b32_dpp v211, v51 row_shr:1 row_mask:0xf bank_mask:0xf bound_ctrl:0
    v_mfma_f32_16x16x32_bf16 v[160:163], v[192:195], v[64:67], v[160:163]
    v_mov_b32_dpp v212, v48 row_ror:1 row_mask:0xf bank_mask:0xf
    v_mov_b32_dpp v213, v49 row_ror:1 row_mask:0xf bank_mask:0xf
    v_mfma_f32_16x16x32_bf16 v[164:167], v[196:199], v[64:67], v[164:167]
    v_mov_b32_dpp v214, v50 row_ror:1 row_mask:0xf bank_mask:0xf
    v_mov_b32_dpp v215, v51 row_ror:1 row_mask:0xf bank_mask:0xf
    v_mfma_f32_16x16x32_bf16 v[168:171], v[192:195], v[52:55], v[168:171]
    v_mov_b32_dpp v212, v52 row_shr:1 row_mask:0xf bank_mask:0xf
    v_mov_b32_dpp v213, v53 row_shr:1 row_mask:0xf bank_mask:0xf
    v_mfma_f32_16x16x32_bf16 v[172:175], v[196:199], v[52:55], v[172:175]
    v_mov_b32_dpp v214, v54 row_shr:1 row_mask:0xf bank_mask:0xf
    v_mov_b32_dpp v215, v55 row_shr:1 row_mask:0xf bank_mask:0xf
    v_mfma_f32_16x16x32_bf16 v[168:171], v[192:195], v[68:71], v[168:171]
    v_mov_b32_dpp v224, v64 row_shr:1 row_mask:0xf bank_mask:0xf bound_ctrl:0
    v_mov_b32_dpp v225, v65 row_shr:1 row_mask:0xf bank_mask:0xf bound_ctrl:0
    v_mfma_f32_16x16x32_bf16 v[172:175], v[196:199], v[68:71], v[172:175]
    v_mov_b32_dpp v226, v66 row_shr:1 row_mask:0xf bank_mask:0xf bound_ctrl:0
    v_mov_b32_dpp v227, v67 row_shr:1 row_mask:0xf bank_mask:0xf bound_ctrl:0
    v_mfma_f32_16x16x32_bf16 v[168:171], v[200:203], v[48:51], v[168:171]
    v_mov_b32_dpp v228, v64 row_ror:1 row_mask:0xf bank_mask:0xf
    v_mov_b32_dpp v229, v65 row_ror:1 row_mask:0xf bank_mask:0xf
    v_mfma_f32_16x16x32_bf16 v[172:175], v[204:207], v[48:51], v[172:175]
    v_mov_b32_dpp v230, v66 row_ror:1 row_mask:0xf bank_mask:0xf
    v_mov_b32_dpp v231, v67 row_ror:1 row_mask:0xf bank_mask:0xf
    v_mfma_f32_16x16x32_bf16 v[168:171], v[200:203], v[64:67], v[168:171]
    v_mov_b32_dpp v228, v68 row_shr:1 row_mask:0xf bank_mask:0xf
    v_mov_b32_dpp v229, v69 row_shr:1 row_mask:0xf bank_mask:0xf
    v_mfma_f32_16x16x32_bf16 v[172:175], v[204:207], v[64:67], v[172:175]
    v_mov_b32_dpp v230, v70 row_shr:1 row_mask:0xf bank_mask:0xf
    v_mov_b32_dpp v231, v71 row_shr:1 row_mask:0xf bank_mask:0xf
    s_sub_u32 s96, s96, 1
    s_cmp_lg_u32 s96, 0
    s_cbranch_scc1 Lcv_10
    s_waitcnt lgkmcnt(0)
    ds_read_b64 v[176:177], v9 offset:0
    ds_read_b64 v[178:179], v9 offset:32
    ds_read_b64 v[180:181], v9 offset:1024
    ds_read_b64 v[182:183], v9 offset:1056
    ds_read_b64 v[184:185], v9 offset:2048
    ds_read_b64 v[186:187], v9 offset:2080
    ds_read_b64 v[188:189], v9 offset:3072
    ds_read_b64 v[190:191], v9 offset:3104
    s_waitcnt lgkmcnt(0)
    v_cvt_pk_bf16_f32 v48, v144, v145
    v_cvt_pk_bf16_f32 v56, v146, v147
    v_cvt_pk_bf16_f32 v64, v148, v149
    v_cvt_pk_bf16_f32 v72, v150, v151
    v_lshlrev_b32 v50, 16, v176
    v_lshlrev_b32 v58, 16, v177
    v_lshlrev_b32 v66, 16, v178
    v_lshlrev_b32 v74, 16, v179
    v_and_b32 v51, 0xffff0000, v176
    v_and_b32 v59, 0xffff0000, v177
    v_and_b32 v67, 0xffff0000, v178
    v_and_b32 v75, 0xffff0000, v179
    v_mul_f32 v50, s85, v50
    v_mul_f32 v58, s85, v58
    v_mul_f32 v66, s85, v66
    v_mul_f32 v74, s85, v74
    v_mul_f32 v51, s85, v51
    v_mul_f32 v59, s85, v59
    v_mul_f32 v67, s85, v67
    v_mul_f32 v75, s85, v75
    v_cvt_pk_bf16_f32 v49, v50, v51
    v_cvt_pk_bf16_f32 v57, v58, v59
    v_cvt_pk_bf16_f32 v65, v66, v67
    v_cvt_pk_bf16_f32 v73, v74, v75
    v_lshlrev_b32 v50, 16, v48
    v_lshlrev_b32 v58, 16, v56
    v_lshlrev_b32 v66, 16, v64
    v_lshlrev_b32 v74, 16, v72
    v_and_b32 v51, 0xffff0000, v48
    v_and_b32 v59, 0xffff0000, v56
    v_and_b32 v67, 0xffff0000, v64
    v_and_b32 v75, 0xffff0000, v72
    v_lshlrev_b32 v52, 16, v49
    v_lshlrev_b32 v60, 16, v57
    v_lshlrev_b32 v68, 16, v65
    v_lshlrev_b32 v76, 16, v73
    v_and_b32 v53, 0xffff0000, v49
    v_and_b32 v61, 0xffff0000, v57
    v_and_b32 v69, 0xffff0000, v65
    v_and_b32 v77, 0xffff0000, v73
    v_pk_add_f32 v[50:51], v[50:51], v[52:53]
    v_pk_add_f32 v[58:59], v[58:59], v[60:61]
    v_pk_add_f32 v[66:67], v[66:67], v[68:69]
    v_pk_add_f32 v[74:75], v[74:75], v[76:77]
    v_cvt_pk_bf16_f32 v120, v50, v51
    v_cvt_pk_bf16_f32 v121, v58, v59
    v_cvt_pk_bf16_f32 v122, v66, v67
    v_cvt_pk_bf16_f32 v123, v74, v75
    ds_write_b64 v9, v[120:121] offset:0
    ds_write_b64 v9, v[122:123] offset:32
    v_cvt_pk_bf16_f32 v48, v152, v153
    v_cvt_pk_bf16_f32 v56, v154, v155
    v_cvt_pk_bf16_f32 v64, v156, v157
    v_cvt_pk_bf16_f32 v72, v158, v159
    v_lshlrev_b32 v50, 16, v180
    v_lshlrev_b32 v58, 16, v181
    v_lshlrev_b32 v66, 16, v182
    v_lshlrev_b32 v74, 16, v183
    v_and_b32 v51, 0xffff0000, v180
    v_and_b32 v59, 0xffff0000, v181
    v_and_b32 v67, 0xffff0000, v182
    v_and_b32 v75, 0xffff0000, v183
    v_mul_f32 v50, s85, v50
    v_mul_f32 v58, s85, v58
    v_mul_f32 v66, s85, v66
    v_mul_f32 v74, s85, v74
    v_mul_f32 v51, s85, v51
    v_mul_f32 v59, s85, v59
    v_mul_f32 v67, s85, v67
    v_mul_f32 v75, s85, v75
    v_cvt_pk_bf16_f32 v49, v50, v51
    v_cvt_pk_bf16_f32 v57, v58, v59
    v_cvt_pk_bf16_f32 v65, v66, v67
    v_cvt_pk_bf16_f32 v73, v74, v75
    v_lshlrev_b32 v50, 16, v48
    v_lshlrev_b32 v58, 16, v56
    v_lshlrev_b32 v66, 16, v64
    v_lshlrev_b32 v74, 16, v72
    v_and_b32 v51, 0xffff0000, v48
    v_and_b32 v59, 0xffff0000, v56
    v_and_b32 v67, 0xffff0000, v64
    v_and_b32 v75, 0xffff0000, v72
    v_lshlrev_b32 v52, 16, v49
    v_lshlrev_b32 v60, 16, v57
    v_lshlrev_b32 v68, 16, v65
    v_lshlrev_b32 v76, 16, v73
    v_and_b32 v53, 0xffff0000, v49
    v_and_b32 v61, 0xffff0000, v57
    v_and_b32 v69, 0xffff0000, v65
    v_and_b32 v77, 0xffff0000, v73
    v_pk_add_f32 v[50:51], v[50:51], v[52:53]
    v_pk_add_f32 v[58:59], v[58:59], v[60:61]
    v_pk_add_f32 v[66:67], v[66:67], v[68:69]
    v_pk_add_f32 v[74:75], v[74:75], v[76:77]
    v_cvt_pk_bf16_f32 v120, v50, v51
    v_cvt_pk_bf16_f32 v121, v58, v59
    v_cvt_pk_bf16_f32 v122, v66, v67
    v_cvt_pk_bf16_f32 v123, v74, v75
    ds_write_b64 v9, v[120:121] offset:1024
    ds_write_b64 v9, v[122:123] offset:1056
    v_cvt_pk_bf16_f32 v48, v160, v161
    v_cvt_pk_bf16_f32 v56, v162, v163
    v_cvt_pk_bf16_f32 v64, v164, v165
    v_cvt_pk_bf16_f32 v72, v166, v167
    v_lshlrev_b32 v50, 16, v184
    v_lshlrev_b32 v58, 16, v185
    v_lshlrev_b32 v66, 16, v186
    v_lshlrev_b32 v74, 16, v187
    v_and_b32 v51, 0xffff0000, v184
    v_and_b32 v59, 0xffff0000, v185
    v_and_b32 v67, 0xffff0000, v186
    v_and_b32 v75, 0xffff0000, v187
    v_mul_f32 v50, s85, v50
    v_mul_f32 v58, s85, v58
    v_mul_f32 v66, s85, v66
    v_mul_f32 v74, s85, v74
    v_mul_f32 v51, s85, v51
    v_mul_f32 v59, s85, v59
    v_mul_f32 v67, s85, v67
    v_mul_f32 v75, s85, v75
    v_cvt_pk_bf16_f32 v49, v50, v51
    v_cvt_pk_bf16_f32 v57, v58, v59
    v_cvt_pk_bf16_f32 v65, v66, v67
    v_cvt_pk_bf16_f32 v73, v74, v75
    v_lshlrev_b32 v50, 16, v48
    v_lshlrev_b32 v58, 16, v56
    v_lshlrev_b32 v66, 16, v64
    v_lshlrev_b32 v74, 16, v72
    v_and_b32 v51, 0xffff0000, v48
    v_and_b32 v59, 0xffff0000, v56
    v_and_b32 v67, 0xffff0000, v64
    v_and_b32 v75, 0xffff0000, v72
    v_lshlrev_b32 v52, 16, v49
    v_lshlrev_b32 v60, 16, v57
    v_lshlrev_b32 v68, 16, v65
    v_lshlrev_b32 v76, 16, v73
    v_and_b32 v53, 0xffff0000, v49
    v_and_b32 v61, 0xffff0000, v57
    v_and_b32 v69, 0xffff0000, v65
    v_and_b32 v77, 0xffff0000, v73
    v_pk_add_f32 v[50:51], v[50:51], v[52:53]
    v_pk_add_f32 v[58:59], v[58:59], v[60:61]
    v_pk_add_f32 v[66:67], v[66:67], v[68:69]
    v_pk_add_f32 v[74:75], v[74:75], v[76:77]
    v_cvt_pk_bf16_f32 v120, v50, v51
    v_cvt_pk_bf16_f32 v121, v58, v59
    v_cvt_pk_bf16_f32 v122, v66, v67
    v_cvt_pk_bf16_f32 v123, v74, v75
    ds_write_b64 v9, v[120:121] offset:2048
    ds_write_b64 v9, v[122:123] offset:2080
    v_cvt_pk_bf16_f32 v48, v168, v169
    v_cvt_pk_bf16_f32 v56, v170, v171
    v_cvt_pk_bf16_f32 v64, v172, v173
    v_cvt_pk_bf16_f32 v72, v174, v175
    v_lshlrev_b32 v50, 16, v188
    v_lshlrev_b32 v58, 16, v189
    v_lshlrev_b32 v66, 16, v190
    v_lshlrev_b32 v74, 16, v191
    v_and_b32 v51, 0xffff0000, v188
    v_and_b32 v59, 0xffff0000, v189
    v_and_b32 v67, 0xffff0000, v190
    v_and_b32 v75, 0xffff0000, v191
    v_mul_f32 v50, s85, v50
    v_mul_f32 v58, s85, v58
    v_mul_f32 v66, s85, v66
    v_mul_f32 v74, s85, v74
    v_mul_f32 v51, s85, v51
    v_mul_f32 v59, s85, v59
    v_mul_f32 v67, s85, v67
    v_mul_f32 v75, s85, v75
    v_cvt_pk_bf16_f32 v49, v50, v51
    v_cvt_pk_bf16_f32 v57, v58, v59
    v_cvt_pk_bf16_f32 v65, v66, v67
    v_cvt_pk_bf16_f32 v73, v74, v75
    v_lshlrev_b32 v50, 16, v48
    v_lshlrev_b32 v58, 16, v56
    v_lshlrev_b32 v66, 16, v64
    v_lshlrev_b32 v74, 16, v72
    v_and_b32 v51, 0xffff0000, v48
    v_and_b32 v59, 0xffff0000, v56
    v_and_b32 v67, 0xffff0000, v64
    v_and_b32 v75, 0xffff0000, v72
    v_lshlrev_b32 v52, 16, v49
    v_lshlrev_b32 v60, 16, v57
    v_lshlrev_b32 v68, 16, v65
    v_lshlrev_b32 v76, 16, v73
    v_and_b32 v53, 0xffff0000, v49
    v_and_b32 v61, 0xffff0000, v57
    v_and_b32 v69, 0xffff0000, v65
    v_and_b32 v77, 0xffff0000, v73
    v_pk_add_f32 v[50:51], v[50:51], v[52:53]
    v_pk_add_f32 v[58:59], v[58:59], v[60:61]
    v_pk_add_f32 v[66:67], v[66:67], v[68:69]
    v_pk_add_f32 v[74:75], v[74:75], v[76:77]
    v_cvt_pk_bf16_f32 v120, v50, v51
    v_cvt_pk_bf16_f32 v121, v58, v59
    v_cvt_pk_bf16_f32 v122, v66, v67
    v_cvt_pk_bf16_f32 v123, v74, v75
    ds_write_b64 v9, v[120:121] offset:3072
    ds_write_b64 v9, v[122:123] offset:3104
    s_waitcnt lgkmcnt(0)
    v_mov_b32 v120, 20832
    v_mov_b32 v121, 1
    v_cmp_eq_u32 vcc, 0, v1
    s_nop 0
    s_and_saveexec_b64 s[42:43], vcc
    ds_add_u32 v120, v121
    s_mov_b64 exec, s[42:43]
    s_nop 0
Lsp_11:
    ds_read_b32 v121, v120
    s_waitcnt lgkmcnt(0)
    v_readfirstlane_b32 s96, v121
    s_nop 0
    s_cmp_lt_u32 s96, 4
    s_nop 2
    s_cbranch_scc1 Lsp_11
    ds_read_b128 v[48:51], v7 offset:0
    ds_read_b128 v[52:55], v7 offset:40960
    ds_read_b128 v[56:59], v141 offset:0
    ds_read_b128 v[60:63], v141 offset:40960
    s_waitcnt vmcnt(0) lgkmcnt(0)
    v_perm_b32 v70, v52, v48, s100
    v_perm_b32 v71, v60, v56, s100
    buffer_store_dwordx2 v[70:71], v3, s[28:31], s68 offen
    v_perm_b32 v72, v52, v48, s101
    v_perm_b32 v73, v60, v56, s101
    buffer_store_dwordx2 v[72:73], v3, s[28:31], s69 offen
    v_perm_b32 v74, v53, v49, s100
    v_perm_b32 v75, v61, v57, s100
    buffer_store_dwordx2 v[74:75], v3, s[28:31], s70 offen
    v_perm_b32 v76, v53, v49, s101
    v_perm_b32 v77, v61, v57, s101
    buffer_store_dwordx2 v[76:77], v3, s[28:31], s71 offen
    v_perm_b32 v70, v54, v50, s100
    v_perm_b32 v71, v62, v58, s100
    buffer_store_dwordx2 v[70:71], v3, s[28:31], s72 offen
    v_perm_b32 v72, v54, v50, s101
    v_perm_b32 v73, v62, v58, s101
    buffer_store_dwordx2 v[72:73], v3, s[28:31], s73 offen
    v_perm_b32 v74, v55, v51, s100
    v_perm_b32 v75, v63, v59, s100
    buffer_store_dwordx2 v[74:75], v3, s[28:31], s74 offen
    v_perm_b32 v76, v55, v51, s101
    v_perm_b32 v77, v63, v59, s101
    buffer_store_dwordx2 v[76:77], v3, s[28:31], s75 offen
    s_nop 3
    s_branch L_done
L_B:
    s_setprio 3
    v_subrev_u32 v124, 24224, v7
    v_subrev_u32 v125, 24224, v141
    v_mov_b32 v122, 20848
    s_nop 4
Lua_12:
    ds_read_b32 v120, v122
    s_waitcnt lgkmcnt(0)
    v_readfirstlane_b32 s96, v120
    s_nop 0
    s_cmp_lt_u32 s96, 4
    s_nop 2
    s_cbranch_scc1 Lua_12
    s_waitcnt vmcnt(11)
    v_perm_b32 v48, v184, v182, s100
    v_perm_b32 v49, v188, v186, s100
    v_perm_b32 v50, v192, v190, s100
    v_perm_b32 v51, v196, v194, s100
    ds_write_b128 v124, v[48:51] offset:0
    v_perm_b32 v52, v184, v182, s101
    v_perm_b32 v53, v188, v186, s101
    v_perm_b32 v54, v192, v190, s101
    v_perm_b32 v55, v196, v194, s101
    ds_write_b128 v124, v[52:55] offset:40960
    v_perm_b32 v56, v185, v183, s100
    v_perm_b32 v57, v189, v187, s100
    v_perm_b32 v58, v193, v191, s100
    v_perm_b32 v59, v197, v195, s100
    ds_write_b128 v125, v[56:59] offset:0
    v_perm_b32 v60, v185, v183, s101
    v_perm_b32 v61, v189, v187, s101
    v_perm_b32 v62, v193, v191, s101
    v_perm_b32 v63, v197, v195, s101
    ds_write_b128 v125, v[60:63] offset:40960
    v_mov_b32 v120, 20840
    v_mov_b32 v121, 1
    s_waitcnt lgkmcnt(0)
    v_cmp_eq_u32 vcc, 0, v1
    s_nop 0
    s_and_saveexec_b64 s[42:43], vcc
    ds_add_u32 v120, v121
    s_mov_b64 exec, s[42:43]
    buffer_load_dwordx2 v[166:167], v2, s[16:19], s68 offen offset:0
    buffer_load_dwordx2 v[168:169], v2, s[16:19], s68 offen offset:2048
    buffer_load_dwordx2 v[170:171], v2, s[16:19], s69 offen offset:0
    buffer_load_dwordx2 v[172:173], v2, s[16:19], s69 offen offset:2048
    buffer_load_dwordx2 v[174:175], v2, s[16:19], s70 offen offset:0
    buffer_load_dwordx2 v[176:177], v2, s[16:19], s70 offen offset:2048
    buffer_load_dwordx2 v[178:179], v2, s[16:19], s71 offen offset:0
    buffer_load_dwordx2 v[180:181], v2, s[16:19], s71 offen offset:2048
    s_waitcnt vmcnt(0)
    v_lshlrev_b32 v200, 16, v144
    v_and_b32 v201, 0xffff0000, v144
    v_lshlrev_b32 v202, 16, v145
    v_and_b32 v203, 0xffff0000, v145
    v_lshlrev_b32 v204, 16, v146
    v_and_b32 v205, 0xffff0000, v146
    v_lshlrev_b32 v206, 16, v147
    v_and_b32 v207, 0xffff0000, v147
    v_lshlrev_b32 v208, 16, v148
    v_and_b32 v209, 0xffff0000, v148
    v_lshlrev_b32 v210, 16, v149
    v_and_b32 v211, 0xffff0000, v149
    v_lshlrev_b32 v212, 16, v150
    v_and_b32 v213, 0xffff0000, v150
    v_lshlrev_b32 v214, 16, v151
    v_and_b32 v215, 0xffff0000, v151
    v_lshlrev_b32 v216, 16, v152
    v_and_b32 v217, 0xffff0000, v152
    v_lshlrev_b32 v218, 16, v153
    v_and_b32 v219, 0xffff0000, v153
    v_lshlrev_b32 v220, 16, v154
    v_and_b32 v221, 0xffff0000, v154
    v_lshlrev_b32 v222, 16, v155
    v_and_b32 v223, 0xffff0000, v155
    v_lshlrev_b32 v224, 16, v156
    v_and_b32 v225, 0xffff0000, v156
    v_lshlrev_b32 v226, 16, v157
    v_and_b32 v227, 0xffff0000, v157
    v_lshlrev_b32 v228, 16, v158
    v_and_b32 v229, 0xffff0000, v158
    v_lshlrev_b32 v230, 16, v159
    v_and_b32 v231, 0xffff0000, v159
    v_lshlrev_b32 v232, 16, v160
    v_and_b32 v233, 0xffff0000, v160
    v_lshlrev_b32 v234, 16, v161
    v_and_b32 v235, 0xffff0000, v161
    v_lshlrev_b32 v236, 16, v162
    v_and_b32 v237, 0xffff0000, v162
    v_lshlrev_b32 v238, 16, v163
    v_and_b32 v239, 0xffff0000, v163
    v_lshlrev_b32 v240, 16, v164
    v_and_b32 v241, 0xffff0000, v164
    v_lshlrev_b32 v242, 16, v165
    v_and_b32 v243, 0xffff0000, v165
    v_mul_f32 v82, s47, v200
    v_mul_f32 v88, s55, v202
    v_mul_f32 v83, s51, v201
    v_mul_f32 v89, s59, v203
    v_cvt_pk_bf16_f32 v84, v82, v83
    v_cvt_pk_bf16_f32 v90, v88, v89
    v_lshlrev_b32 v80, 16, v84
    v_lshlrev_b32 v86, 16, v90
    v_and_b32 v81, 0xffff0000, v84
    v_and_b32 v87, 0xffff0000, v90
    v_mul_f32 v82, s46, v204
    v_mul_f32 v88, s54, v206
    v_mul_f32 v83, s50, v205
    v_mul_f32 v89, s58, v207
    v_cvt_pk_bf16_f32 v84, v82, v83
    v_cvt_pk_bf16_f32 v90, v88, v89
    v_lshlrev_b32 v82, 16, v84
    v_lshlrev_b32 v88, 16, v90
    v_and_b32 v83, 0xffff0000, v84
    v_and_b32 v89, 0xffff0000, v90
    v_pk_add_f32 v[82:83], v[80:81], v[82:83]
    v_pk_add_f32 v[88:89], v[86:87], v[88:89]
    v_cvt_pk_bf16_f32 v84, v82, v83
    v_cvt_pk_bf16_f32 v90, v88, v89
    v_lshlrev_b32 v80, 16, v84
    v_lshlrev_b32 v86, 16, v90
    v_and_b32 v81, 0xffff0000, v84
    v_and_b32 v87, 0xffff0000, v90
    v_mul_f32 v82, s45, v208
    v_mul_f32 v88, s53, v210
    v_mul_f32 v83, s49, v209
    v_mul_f32 v89, s57, v211
    v_cvt_pk_bf16_f32 v84, v82, v83
    v_cvt_pk_bf16_f32 v90, v88, v89
    v_lshlrev_b32 v82, 16, v84
    v_lshlrev_b32 v88, 16, v90
    v_and_b32 v83, 0xffff0000, v84
    v_and_b32 v89, 0xffff0000, v90
    v_pk_add_f32 v[82:83], v[80:81], v[82:83]
    v_pk_add_f32 v[88:89], v[86:87], v[88:89]
    v_cvt_pk_bf16_f32 v84, v82, v83
    v_cvt_pk_bf16_f32 v90, v88, v89
    v_lshlrev_b32 v80, 16, v84
    v_lshlrev_b32 v86, 16, v90
    v_and_b32 v81, 0xffff0000, v84
    v_and_b32 v87, 0xffff0000, v90
    v_mul_f32 v82, s44, v212
    v_mul_f32 v88, s52, v214
    v_mul_f32 v83, s48, v213
    v_mul_f32 v89, s56, v215
    v_cvt_pk_bf16_f32 v84, v82, v83
    v_cvt_pk_bf16_f32 v90, v88, v89
    v_lshlrev_b32 v82, 16, v84
    v_lshlrev_b32 v88, 16, v90
    v_and_b32 v83, 0xffff0000, v84
    v_and_b32 v89, 0xffff0000, v90
    v_pk_add_f32 v[82:83], v[80:81], v[82:83]
    v_pk_add_f32 v[88:89], v[86:87], v[88:89]
    v_cvt_pk_bf16_f32 v84, v82, v83
    v_cvt_pk_bf16_f32 v90, v88, v89
    v_lshlrev_b32 v80, 16, v84
    v_lshlrev_b32 v86, 16, v90
    v_and_b32 v81, 0xffff0000, v84
    v_and_b32 v87, 0xffff0000, v90
    v_lshlrev_b32 v82, 16, v166
    v_lshlrev_b32 v88, 16, v167
    v_and_b32 v83, 0xffff0000, v166
    v_and_b32 v89, 0xffff0000, v167
    v_pk_mul_f32 v[82:83], v[80:81], v[82:83]
    v_pk_mul_f32 v[88:89], v[86:87], v[88:89]
    v_cvt_pk_bf16_f32 v10, v82, v83
    v_cvt_pk_bf16_f32 v11, v88, v89
    v_mul_f32 v82, s47, v204
    v_mul_f32 v88, s55, v206
    v_mul_f32 v83, s51, v205
    v_mul_f32 v89, s59, v207
    v_cvt_pk_bf16_f32 v84, v82, v83
    v_cvt_pk_bf16_f32 v90, v88, v89
    v_lshlrev_b32 v80, 16, v84
    v_lshlrev_b32 v86, 16, v90
    v_and_b32 v81, 0xffff0000, v84
    v_and_b32 v87, 0xffff0000, v90
    v_mul_f32 v82, s46, v208
    v_mul_f32 v88, s54, v210
    v_mul_f32 v83, s50, v209
    v_mul_f32 v89, s58, v211
    v_cvt_pk_bf16_f32 v84, v82, v83
    v_cvt_pk_bf16_f32 v90, v88, v89
    v_lshlrev_b32 v82, 16, v84
    v_lshlrev_b32 v88, 16, v90
    v_and_b32 v83, 0xffff0000, v84
    v_and_b32 v89, 0xffff0000, v90
    v_pk_add_f32 v[82:83], v[80:81], v[82:83]
    v_pk_add_f32 v[88:89], v[86:87], v[88:89]
    v_cvt_pk_bf16_f32 v84, v82, v83
    v_cvt_pk_bf16_f32 v90, v88, v89
    v_lshlrev_b32 v80, 16, v84
    v_lshlrev_b32 v86, 16, v90
    v_and_b32 v81, 0xffff0000, v84
    v_and_b32 v87, 0xffff0000, v90
    v_mul_f32 v82, s45, v212
    v_mul_f32 v88, s53, v214
    v_mul_f32 v83, s49, v213
    v_mul_f32 v89, s57, v215
    v_cvt_pk_bf16_f32 v84, v82, v83
    v_cvt_pk_bf16_f32 v90, v88, v89
    v_lshlrev_b32 v82, 16, v84
    v_lshlrev_b32 v88, 16, v90
    v_and_b32 v83, 0xffff0000, v84
    v_and_b32 v89, 0xffff0000, v90
    v_pk_add_f32 v[82:83], v[80:81], v[82:83]
    v_pk_add_f32 v[88:89], v[86:87], v[88:89]
    v_cvt_pk_bf16_f32 v84, v82, v83
    v_cvt_pk_bf16_f32 v90, v88, v89
    v_lshlrev_b32 v80, 16, v84
    v_lshlrev_b32 v86, 16, v90
    v_and_b32 v81, 0xffff0000, v84
    v_and_b32 v87, 0xffff0000, v90
    v_mul_f32 v82, s44, v216
    v_mul_f32 v88, s52, v218
    v_mul_f32 v83, s48, v217
    v_mul_f32 v89, s56, v219
    v_cvt_pk_bf16_f32 v84, v82, v83
    v_cvt_pk_bf16_f32 v90, v88, v89
    v_lshlrev_b32 v82, 16, v84
    v_lshlrev_b32 v88, 16, v90
    v_and_b32 v83, 0xffff0000, v84
    v_and_b32 v89, 0xffff0000, v90
    v_pk_add_f32 v[82:83], v[80:81], v[82:83]
    v_pk_add_f32 v[88:89], v[86:87], v[88:89]
    v_cvt_pk_bf16_f32 v84, v82, v83
    v_cvt_pk_bf16_f32 v90, v88, v89
    v_lshlrev_b32 v80, 16, v84
    v_lshlrev_b32 v86, 16, v90
    v_and_b32 v81, 0xffff0000, v84
    v_and_b32 v87, 0xffff0000, v90
    v_lshlrev_b32 v82, 16, v168
    v_lshlrev_b32 v88, 16, v169
    v_and_b32 v83, 0xffff0000, v168
    v_and_b32 v89, 0xffff0000, v169
    v_pk_mul_f32 v[82:83], v[80:81], v[82:83]
    v_pk_mul_f32 v[88:89], v[86:87], v[88:89]
    v_cvt_pk_bf16_f32 v12, v82, v83
    v_cvt_pk_bf16_f32 v13, v88, v89
    v_mul_f32 v82, s47, v208
    v_mul_f32 v88, s55, v210
    v_mul_f32 v83, s51, v209
    v_mul_f32 v89, s59, v211
    v_cvt_pk_bf16_f32 v84, v82, v83
    v_cvt_pk_bf16_f32 v90, v88, v89
    v_lshlrev_b32 v80, 16, v84
    v_lshlrev_b32 v86, 16, v90
    v_and_b32 v81, 0xffff0000, v84
    v_and_b32 v87, 0xffff0000, v90
    v_mul_f32 v82, s46, v212
    v_mul_f32 v88, s54, v214
    v_mul_f32 v83, s50, v213
    v_mul_f32 v89, s58, v215
    v_cvt_pk_bf16_f32 v84, v82, v83
    v_cvt_pk_bf16_f32 v90, v88, v89
    v_lshlrev_b32 v82, 16, v84
    v_lshlrev_b32 v88, 16, v90
    v_and_b32 v83, 0xffff0000, v84
    v_and_b32 v89, 0xffff0000, v90
    v_pk_add_f32 v[82:83], v[80:81], v[82:83]
    v_pk_add_f32 v[88:89], v[86:87], v[88:89]
    v_cvt_pk_bf16_f32 v84, v82, v83
    v_cvt_pk_bf16_f32 v90, v88, v89
    v_lshlrev_b32 v80, 16, v84
    v_lshlrev_b32 v86, 16, v90
    v_and_b32 v81, 0xffff0000, v84
    v_and_b32 v87, 0xffff0000, v90
    v_mul_f32 v82, s45, v216
    v_mul_f32 v88, s53, v218
    v_mul_f32 v83, s49, v217
    v_mul_f32 v89, s57, v219
    v_cvt_pk_bf16_f32 v84, v82, v83
    v_cvt_pk_bf16_f32 v90, v88, v89
    v_lshlrev_b32 v82, 16, v84
    v_lshlrev_b32 v88, 16, v90
    v_and_b32 v83, 0xffff0000, v84
    v_and_b32 v89, 0xffff0000, v90
    v_pk_add_f32 v[82:83], v[80:81], v[82:83]
    v_pk_add_f32 v[88:89], v[86:87], v[88:89]
    v_cvt_pk_bf16_f32 v84, v82, v83
    v_cvt_pk_bf16_f32 v90, v88, v89
    v_lshlrev_b32 v80, 16, v84
    v_lshlrev_b32 v86, 16, v90
    v_and_b32 v81, 0xffff0000, v84
    v_and_b32 v87, 0xffff0000, v90
    v_mul_f32 v82, s44, v220
    v_mul_f32 v88, s52, v222
    v_mul_f32 v83, s48, v221
    v_mul_f32 v89, s56, v223
    v_cvt_pk_bf16_f32 v84, v82, v83
    v_cvt_pk_bf16_f32 v90, v88, v89
    v_lshlrev_b32 v82, 16, v84
    v_lshlrev_b32 v88, 16, v90
    v_and_b32 v83, 0xffff0000, v84
    v_and_b32 v89, 0xffff0000, v90
    v_pk_add_f32 v[82:83], v[80:81], v[82:83]
    v_pk_add_f32 v[88:89], v[86:87], v[88:89]
    v_cvt_pk_bf16_f32 v84, v82, v83
    v_cvt_pk_bf16_f32 v90, v88, v89
    v_lshlrev_b32 v80, 16, v84
    v_lshlrev_b32 v86, 16, v90
    v_and_b32 v81, 0xffff0000, v84
    v_and_b32 v87, 0xffff0000, v90
    v_lshlrev_b32 v82, 16, v170
    v_lshlrev_b32 v88, 16, v171
    v_and_b32 v83, 0xffff0000, v170
    v_and_b32 v89, 0xffff0000, v171
    v_pk_mul_f32 v[82:83], v[80:81], v[82:83]
    v_pk_mul_f32 v[88:89], v[86:87], v[88:89]
    v_cvt_pk_bf16_f32 v14, v82, v83
    v_cvt_pk_bf16_f32 v15, v88, v89
    v_mul_f32 v82, s47, v212
    v_mul_f32 v88, s55, v214
    v_mul_f32 v83, s51, v213
    v_mul_f32 v89, s59, v215
    v_cvt_pk_bf16_f32 v84, v82, v83
    v_cvt_pk_bf16_f32 v90, v88, v89
    v_lshlrev_b32 v80, 16, v84
    v_lshlrev_b32 v86, 16, v90
    v_and_b32 v81, 0xffff0000, v84
    v_and_b32 v87, 0xffff0000, v90
    v_mul_f32 v82, s46, v216
    v_mul_f32 v88, s54, v218
    v_mul_f32 v83, s50, v217
    v_mul_f32 v89, s58, v219
    v_cvt_pk_bf16_f32 v84, v82, v83
    v_cvt_pk_bf16_f32 v90, v88, v89
    v_lshlrev_b32 v82, 16, v84
    v_lshlrev_b32 v88, 16, v90
    v_and_b32 v83, 0xffff0000, v84
    v_and_b32 v89, 0xffff0000, v90
    v_pk_add_f32 v[82:83], v[80:81], v[82:83]
    v_pk_add_f32 v[88:89], v[86:87], v[88:89]
    v_cvt_pk_bf16_f32 v84, v82, v83
    v_cvt_pk_bf16_f32 v90, v88, v89
    v_lshlrev_b32 v80, 16, v84
    v_lshlrev_b32 v86, 16, v90
    v_and_b32 v81, 0xffff0000, v84
    v_and_b32 v87, 0xffff0000, v90
    v_mul_f32 v82, s45, v220
    v_mul_f32 v88, s53, v222
    v_mul_f32 v83, s49, v221
    v_mul_f32 v89, s57, v223
    v_cvt_pk_bf16_f32 v84, v82, v83
    v_cvt_pk_bf16_f32 v90, v88, v89
    v_lshlrev_b32 v82, 16, v84
    v_lshlrev_b32 v88, 16, v90
    v_and_b32 v83, 0xffff0000, v84
    v_and_b32 v89, 0xffff0000, v90
    v_pk_add_f32 v[82:83], v[80:81], v[82:83]
    v_pk_add_f32 v[88:89], v[86:87], v[88:89]
    v_cvt_pk_bf16_f32 v84, v82, v83
    v_cvt_pk_bf16_f32 v90, v88, v89
    v_lshlrev_b32 v80, 16, v84
    v_lshlrev_b32 v86, 16, v90
    v_and_b32 v81, 0xffff0000, v84
    v_and_b32 v87, 0xffff0000, v90
    v_mul_f32 v82, s44, v224
    v_mul_f32 v88, s52, v226
    v_mul_f32 v83, s48, v225
    v_mul_f32 v89, s56, v227
    v_cvt_pk_bf16_f32 v84, v82, v83
    v_cvt_pk_bf16_f32 v90, v88, v89
    v_lshlrev_b32 v82, 16, v84
    v_lshlrev_b32 v88, 16, v90
    v_and_b32 v83, 0xffff0000, v84
    v_and_b32 v89, 0xffff0000, v90
    v_pk_add_f32 v[82:83], v[80:81], v[82:83]
    v_pk_add_f32 v[88:89], v[86:87], v[88:89]
    v_cvt_pk_bf16_f32 v84, v82, v83
    v_cvt_pk_bf16_f32 v90, v88, v89
    v_lshlrev_b32 v80, 16, v84
    v_lshlrev_b32 v86, 16, v90
    v_and_b32 v81, 0xffff0000, v84
    v_and_b32 v87, 0xffff0000, v90
    v_lshlrev_b32 v82, 16, v172
    v_lshlrev_b32 v88, 16, v173
    v_and_b32 v83, 0xffff0000, v172
    v_and_b32 v89, 0xffff0000, v173
    v_pk_mul_f32 v[82:83], v[80:81], v[82:83]
    v_pk_mul_f32 v[88:89], v[86:87], v[88:89]
    v_cvt_pk_bf16_f32 v16, v82, v83
    v_cvt_pk_bf16_f32 v17, v88, v89
    v_mul_f32 v82, s47, v216
    v_mul_f32 v88, s55, v218
    v_mul_f32 v83, s51, v217
    v_mul_f32 v89, s59, v219
    v_cvt_pk_bf16_f32 v84, v82, v83
    v_cvt_pk_bf16_f32 v90, v88, v89
    v_lshlrev_b32 v80, 16, v84
    v_lshlrev_b32 v86, 16, v90
    v_and_b32 v81, 0xffff0000, v84
    v_and_b32 v87, 0xffff0000, v90
    v_mul_f32 v82, s46, v220
    v_mul_f32 v88, s54, v222
    v_mul_f32 v83, s50, v221
    v_mul_f32 v89, s58, v223
    v_cvt_pk_bf16_f32 v84, v82, v83
    v_cvt_pk_bf16_f32 v90, v88, v89
    v_lshlrev_b32 v82, 16, v84
    v_lshlrev_b32 v88, 16, v90
    v_and_b32 v83, 0xffff0000, v84
    v_and_b32 v89, 0xffff0000, v90
    v_pk_add_f32 v[82:83], v[80:81], v[82:83]
    v_pk_add_f32 v[88:89], v[86:87], v[88:89]
    v_cvt_pk_bf16_f32 v84, v82, v83
    v_cvt_pk_bf16_f32 v90, v88, v89
    v_lshlrev_b32 v80, 16, v84
    v_lshlrev_b32 v86, 16, v90
    v_and_b32 v81, 0xffff0000, v84
    v_and_b32 v87, 0xffff0000, v90
    v_mul_f32 v82, s45, v224
    v_mul_f32 v88, s53, v226
    v_mul_f32 v83, s49, v225
    v_mul_f32 v89, s57, v227
    v_cvt_pk_bf16_f32 v84, v82, v83
    v_cvt_pk_bf16_f32 v90, v88, v89
    v_lshlrev_b32 v82, 16, v84
    v_lshlrev_b32 v88, 16, v90
    v_and_b32 v83, 0xffff0000, v84
    v_and_b32 v89, 0xffff0000, v90
    v_pk_add_f32 v[82:83], v[80:81], v[82:83]
    v_pk_add_f32 v[88:89], v[86:87], v[88:89]
    v_cvt_pk_bf16_f32 v84, v82, v83
    v_cvt_pk_bf16_f32 v90, v88, v89
    v_lshlrev_b32 v80, 16, v84
    v_lshlrev_b32 v86, 16, v90
    v_and_b32 v81, 0xffff0000, v84
    v_and_b32 v87, 0xffff0000, v90
    v_mul_f32 v82, s44, v228
    v_mul_f32 v88, s52, v230
    v_mul_f32 v83, s48, v229
    v_mul_f32 v89, s56, v231
    v_cvt_pk_bf16_f32 v84, v82, v83
    v_cvt_pk_bf16_f32 v90, v88, v89
    v_lshlrev_b32 v82, 16, v84
    v_lshlrev_b32 v88, 16, v90
    v_and_b32 v83, 0xffff0000, v84
    v_and_b32 v89, 0xffff0000, v90
    v_pk_add_f32 v[82:83], v[80:81], v[82:83]
    v_pk_add_f32 v[88:89], v[86:87], v[88:89]
    v_cvt_pk_bf16_f32 v84, v82, v83
    v_cvt_pk_bf16_f32 v90, v88, v89
    v_lshlrev_b32 v80, 16, v84
    v_lshlrev_b32 v86, 16, v90
    v_and_b32 v81, 0xffff0000, v84
    v_and_b32 v87, 0xffff0000, v90
    v_lshlrev_b32 v82, 16, v174
    v_lshlrev_b32 v88, 16, v175
    v_and_b32 v83, 0xffff0000, v174
    v_and_b32 v89, 0xffff0000, v175
    v_pk_mul_f32 v[82:83], v[80:81], v[82:83]
    v_pk_mul_f32 v[88:89], v[86:87], v[88:89]
    v_cvt_pk_bf16_f32 v18, v82, v83
    v_cvt_pk_bf16_f32 v19, v88, v89
    v_mul_f32 v82, s47, v220
    v_mul_f32 v88, s55, v222
    v_mul_f32 v83, s51, v221
    v_mul_f32 v89, s59, v223
    v_cvt_pk_bf16_f32 v84, v82, v83
    v_cvt_pk_bf16_f32 v90, v88, v89
    v_lshlrev_b32 v80, 16, v84
    v_lshlrev_b32 v86, 16, v90
    v_and_b32 v81, 0xffff0000, v84
    v_and_b32 v87, 0xffff0000, v90
    v_mul_f32 v82, s46, v224
    v_mul_f32 v88, s54, v226
    v_mul_f32 v83, s50, v225
    v_mul_f32 v89, s58, v227
    v_cvt_pk_bf16_f32 v84, v82, v83
    v_cvt_pk_bf16_f32 v90, v88, v89
    v_lshlrev_b32 v82, 16, v84
    v_lshlrev_b32 v88, 16, v90
    v_and_b32 v83, 0xffff0000, v84
    v_and_b32 v89, 0xffff0000, v90
    v_pk_add_f32 v[82:83], v[80:81], v[82:83]
    v_pk_add_f32 v[88:89], v[86:87], v[88:89]
    v_cvt_pk_bf16_f32 v84, v82, v83
    v_cvt_pk_bf16_f32 v90, v88, v89
    v_lshlrev_b32 v80, 16, v84
    v_lshlrev_b32 v86, 16, v90
    v_and_b32 v81, 0xffff0000, v84
    v_and_b32 v87, 0xffff0000, v90
    v_mul_f32 v82, s45, v228
    v_mul_f32 v88, s53, v230
    v_mul_f32 v83, s49, v229
    v_mul_f32 v89, s57, v231
    v_cvt_pk_bf16_f32 v84, v82, v83
    v_cvt_pk_bf16_f32 v90, v88, v89
    v_lshlrev_b32 v82, 16, v84
    v_lshlrev_b32 v88, 16, v90
    v_and_b32 v83, 0xffff0000, v84
    v_and_b32 v89, 0xffff0000, v90
    v_pk_add_f32 v[82:83], v[80:81], v[82:83]
    v_pk_add_f32 v[88:89], v[86:87], v[88:89]
    v_cvt_pk_bf16_f32 v84, v82, v83
    v_cvt_pk_bf16_f32 v90, v88, v89
    v_lshlrev_b32 v80, 16, v84
    v_lshlrev_b32 v86, 16, v90
    v_and_b32 v81, 0xffff0000, v84
    v_and_b32 v87, 0xffff0000, v90
    v_mul_f32 v82, s44, v232
    v_mul_f32 v88, s52, v234
    v_mul_f32 v83, s48, v233
    v_mul_f32 v89, s56, v235
    v_cvt_pk_bf16_f32 v84, v82, v83
    v_cvt_pk_bf16_f32 v90, v88, v89
    v_lshlrev_b32 v82, 16, v84
    v_lshlrev_b32 v88, 16, v90
    v_and_b32 v83, 0xffff0000, v84
    v_and_b32 v89, 0xffff0000, v90
    v_pk_add_f32 v[82:83], v[80:81], v[82:83]
    v_pk_add_f32 v[88:89], v[86:87], v[88:89]
    v_cvt_pk_bf16_f32 v84, v82, v83
    v_cvt_pk_bf16_f32 v90, v88, v89
    v_lshlrev_b32 v80, 16, v84
    v_lshlrev_b32 v86, 16, v90
    v_and_b32 v81, 0xffff0000, v84
    v_and_b32 v87, 0xffff0000, v90
    v_lshlrev_b32 v82, 16, v176
    v_lshlrev_b32 v88, 16, v177
    v_and_b32 v83, 0xffff0000, v176
    v_and_b32 v89, 0xffff0000, v177
    v_pk_mul_f32 v[82:83], v[80:81], v[82:83]
    v_pk_mul_f32 v[88:89], v[86:87], v[88:89]
    v_cvt_pk_bf16_f32 v20, v82, v83
    v_cvt_pk_bf16_f32 v21, v88, v89
    v_mul_f32 v82, s47, v224
    v_mul_f32 v88, s55, v226
    v_mul_f32 v83, s51, v225
    v_mul_f32 v89, s59, v227
    v_cvt_pk_bf16_f32 v84, v82, v83
    v_cvt_pk_bf16_f32 v90, v88, v89
    v_lshlrev_b32 v80, 16, v84
    v_lshlrev_b32 v86, 16, v90
    v_and_b32 v81, 0xffff0000, v84
    v_and_b32 v87, 0xffff0000, v90
    v_mul_f32 v82, s46, v228
    v_mul_f32 v88, s54, v230
    v_mul_f32 v83, s50, v229
    v_mul_f32 v89, s58, v231
    v_cvt_pk_bf16_f32 v84, v82, v83
    v_cvt_pk_bf16_f32 v90, v88, v89
    v_lshlrev_b32 v82, 16, v84
    v_lshlrev_b32 v88, 16, v90
    v_and_b32 v83, 0xffff0000, v84
    v_and_b32 v89, 0xffff0000, v90
    v_pk_add_f32 v[82:83], v[80:81], v[82:83]
    v_pk_add_f32 v[88:89], v[86:87], v[88:89]
    v_cvt_pk_bf16_f32 v84, v82, v83
    v_cvt_pk_bf16_f32 v90, v88, v89
    v_lshlrev_b32 v80, 16, v84
    v_lshlrev_b32 v86, 16, v90
    v_and_b32 v81, 0xffff0000, v84
    v_and_b32 v87, 0xffff0000, v90
    v_mul_f32 v82, s45, v232
    v_mul_f32 v88, s53, v234
    v_mul_f32 v83, s49, v233
    v_mul_f32 v89, s57, v235
    v_cvt_pk_bf16_f32 v84, v82, v83
    v_cvt_pk_bf16_f32 v90, v88, v89
    v_lshlrev_b32 v82, 16, v84
    v_lshlrev_b32 v88, 16, v90
    v_and_b32 v83, 0xffff0000, v84
    v_and_b32 v89, 0xffff0000, v90
    v_pk_add_f32 v[82:83], v[80:81], v[82:83]
    v_pk_add_f32 v[88:89], v[86:87], v[88:89]
    v_cvt_pk_bf16_f32 v84, v82, v83
    v_cvt_pk_bf16_f32 v90, v88, v89
    v_lshlrev_b32 v80, 16, v84
    v_lshlrev_b32 v86, 16, v90
    v_and_b32 v81, 0xffff0000, v84
    v_and_b32 v87, 0xffff0000, v90
    v_mul_f32 v82, s44, v236
    v_mul_f32 v88, s52, v238
    v_mul_f32 v83, s48, v237
    v_mul_f32 v89, s56, v239
    v_cvt_pk_bf16_f32 v84, v82, v83
    v_cvt_pk_bf16_f32 v90, v88, v89
    v_lshlrev_b32 v82, 16, v84
    v_lshlrev_b32 v88, 16, v90
    v_and_b32 v83, 0xffff0000, v84
    v_and_b32 v89, 0xffff0000, v90
    v_pk_add_f32 v[82:83], v[80:81], v[82:83]
    v_pk_add_f32 v[88:89], v[86:87], v[88:89]
    v_cvt_pk_bf16_f32 v84, v82, v83
    v_cvt_pk_bf16_f32 v90, v88, v89
    v_lshlrev_b32 v80, 16, v84
    v_lshlrev_b32 v86, 16, v90
    v_and_b32 v81, 0xffff0000, v84
    v_and_b32 v87, 0xffff0000, v90
    v_lshlrev_b32 v82, 16, v178
    v_lshlrev_b32 v88, 16, v179
    v_and_b32 v83, 0xffff0000, v178
    v_and_b32 v89, 0xffff0000, v179
    v_pk_mul_f32 v[82:83], v[80:81], v[82:83]
    v_pk_mul_f32 v[88:89], v[86:87], v[88:89]
    v_cvt_pk_bf16_f32 v22, v82, v83
    v_cvt_pk_bf16_f32 v23, v88, v89
    v_mul_f32 v82, s47, v228
    v_mul_f32 v88, s55, v230
    v_mul_f32 v83, s51, v229
    v_mul_f32 v89, s59, v231
    v_cvt_pk_bf16_f32 v84, v82, v83
    v_cvt_pk_bf16_f32 v90, v88, v89
    v_lshlrev_b32 v80, 16, v84
    v_lshlrev_b32 v86, 16, v90
    v_and_b32 v81, 0xffff0000, v84
    v_and_b32 v87, 0xffff0000, v90
    v_mul_f32 v82, s46, v232
    v_mul_f32 v88, s54, v234
    v_mul_f32 v83, s50, v233
    v_mul_f32 v89, s58, v235
    v_cvt_pk_bf16_f32 v84, v82, v83
    v_cvt_pk_bf16_f32 v90, v88, v89
    v_lshlrev_b32 v82, 16, v84
    v_lshlrev_b32 v88, 16, v90
    v_and_b32 v83, 0xffff0000, v84
    v_and_b32 v89, 0xffff0000, v90
    v_pk_add_f32 v[82:83], v[80:81], v[82:83]
    v_pk_add_f32 v[88:89], v[86:87], v[88:89]
    v_cvt_pk_bf16_f32 v84, v82, v83
    v_cvt_pk_bf16_f32 v90, v88, v89
    v_lshlrev_b32 v80, 16, v84
    v_lshlrev_b32 v86, 16, v90
    v_and_b32 v81, 0xffff0000, v84
    v_and_b32 v87, 0xffff0000, v90
    v_mul_f32 v82, s45, v236
    v_mul_f32 v88, s53, v238
    v_mul_f32 v83, s49, v237
    v_mul_f32 v89, s57, v239
    v_cvt_pk_bf16_f32 v84, v82, v83
    v_cvt_pk_bf16_f32 v90, v88, v89
    v_lshlrev_b32 v82, 16, v84
    v_lshlrev_b32 v88, 16, v90
    v_and_b32 v83, 0xffff0000, v84
    v_and_b32 v89, 0xffff0000, v90
    v_pk_add_f32 v[82:83], v[80:81], v[82:83]
    v_pk_add_f32 v[88:89], v[86:87], v[88:89]
    v_cvt_pk_bf16_f32 v84, v82, v83
    v_cvt_pk_bf16_f32 v90, v88, v89
    v_lshlrev_b32 v80, 16, v84
    v_lshlrev_b32 v86, 16, v90
    v_and_b32 v81, 0xffff0000, v84
    v_and_b32 v87, 0xffff0000, v90
    v_mul_f32 v82, s44, v240
    v_mul_f32 v88, s52, v242
    v_mul_f32 v83, s48, v241
    v_mul_f32 v89, s56, v243
    v_cvt_pk_bf16_f32 v84, v82, v83
    v_cvt_pk_bf16_f32 v90, v88, v89
    v_lshlrev_b32 v82, 16, v84
    v_lshlrev_b32 v88, 16, v90
    v_and_b32 v83, 0xffff0000, v84
    v_and_b32 v89, 0xffff0000, v90
    v_pk_add_f32 v[82:83], v[80:81], v[82:83]
    v_pk_add_f32 v[88:89], v[86:87], v[88:89]
    v_cvt_pk_bf16_f32 v84, v82, v83
    v_cvt_pk_bf16_f32 v90, v88, v89
    v_lshlrev_b32 v80, 16, v84
    v_lshlrev_b32 v86, 16, v90
    v_and_b32 v81, 0xffff0000, v84
    v_and_b32 v87, 0xffff0000, v90
    v_lshlrev_b32 v82, 16, v180
    v_lshlrev_b32 v88, 16, v181
    v_and_b32 v83, 0xffff0000, v180
    v_and_b32 v89, 0xffff0000, v181
    v_pk_mul_f32 v[82:83], v[80:81], v[82:83]
    v_pk_mul_f32 v[88:89], v[86:87], v[88:89]
    v_cvt_pk_bf16_f32 v24, v82, v83
    v_cvt_pk_bf16_f32 v25, v88, v89
    v_perm_b32 v48, v12, v10, s100
    v_perm_b32 v49, v16, v14, s100
    v_perm_b32 v50, v20, v18, s100
    v_perm_b32 v51, v24, v22, s100
    ds_write_b128 v7, v[48:51] offset:0
    v_perm_b32 v52, v12, v10, s101
    v_perm_b32 v53, v16, v14, s101
    v_perm_b32 v54, v20, v18, s101
    v_perm_b32 v55, v24, v22, s101
    ds_write_b128 v7, v[52:55] offset:40960
    v_perm_b32 v56, v13, v11, s100
    v_perm_b32 v57, v17, v15, s100
    v_perm_b32 v58, v21, v19, s100
    v_perm_b32 v59, v25, v23, s100
    ds_write_b128 v141, v[56:59] offset:0
    v_perm_b32 v60, v13, v11, s101
    v_perm_b32 v61, v17, v15, s101
    v_perm_b32 v62, v21, v19, s101
    v_perm_b32 v63, v25, v23, s101
    ds_write_b128 v141, v[60:63] offset:40960
    s_waitcnt lgkmcnt(0)
    v_mov_b32 v120, 20844
    v_mov_b32 v121, 1
    v_cmp_eq_u32 vcc, 0, v1
    s_nop 0
    s_and_saveexec_b64 s[42:43], vcc
    ds_add_u32 v120, v121
    s_mov_b64 exec, s[42:43]
    s_nop 0
Lsp_13:
    ds_read_b32 v121, v120
    s_waitcnt lgkmcnt(0)
    v_readfirstlane_b32 s96, v121
    s_nop 0
    s_cmp_lt_u32 s96, 4
    s_nop 2
    s_cbranch_scc1 Lsp_13
    s_setprio 2
    ds_write_b128 v26, v[96:99] offset:0
    ds_write_b128 v26, v[100:103] offset:1024
    ds_write_b128 v26, v[104:107] offset:2048
    ds_write_b128 v26, v[108:111] offset:3072
    s_waitcnt vmcnt(0)
    v_lshlrev_b32 v120, 2, v1
    v_add_u32 v120, s39, v120
    v_mov_b32 v121, 0
    v_cmp_gt_u32 vcc, 16, v1
    s_nop 0
    s_and_saveexec_b64 s[42:43], vcc
    ds_write_b32 v120, v121
    s_mov_b64 exec, s[42:43]
    v_mov_b32 v144, 0
    v_mov_b32 v145, 0
    v_mov_b32 v146, 0
    v_mov_b32 v147, 0
    v_mov_b32 v148, 0
    v_mov_b32 v149, 0
    v_mov_b32 v150, 0
    v_mov_b32 v151, 0
    v_mov_b32 v152, 0
    v_mov_b32 v153, 0
    v_mov_b32 v154, 0
    v_mov_b32 v155, 0
    v_mov_b32 v156, 0
    v_mov_b32 v157, 0
    v_mov_b32 v158, 0
    v_mov_b32 v159, 0
    v_mov_b32 v160, 0
    v_mov_b32 v161, 0
    v_mov_b32 v162, 0
    v_mov_b32 v163, 0
    v_mov_b32 v164, 0
    v_mov_b32 v165, 0
    v_mov_b32 v166, 0
    v_mov_b32 v167, 0
    v_mov_b32 v168, 0
    v_mov_b32 v169, 0
    v_mov_b32 v170, 0
    v_mov_b32 v171, 0
    v_mov_b32 v172, 0
    v_mov_b32 v173, 0
    v_mov_b32 v174, 0
    v_mov_b32 v175, 0
    s_waitcnt lgkmcnt(0)
    v_add_u32 v133, 0, v138
    v_mov_b32 v134, v139
    v_mov_b32 v135, v1
    s_mov_b32 s96, 5
Lcp_14:
    ds_read_b64 v[120:121], v133
    ds_read_b64 v[122:123], v133 offset:8
    v_cmp_gt_u32 vcc, 263, v135
    v_subrev_u32 v133, 512, v133
    v_add_u32 v135, 64, v135
    s_waitcnt lgkmcnt(0)
    v_alignbit_b32 v240, v123, v123, 16
    v_alignbit_b32 v241, v122, v122, 16
    v_bfi_b32 v242, v140, v123, v122
    v_bfi_b32 v243, v140, v122, v121
    v_mov_b32 v244, v241
    v_alignbit_b32 v245, v121, v121, 16
    v_mov_b32 v246, v243
    v_bfi_b32 v247, v140, v121, v120
    s_and_saveexec_b64 s[42:43], vcc
    ds_write_b128 v134, v[240:243]
    ds_write_b128 v134, v[244:247] offset:16
    s_mov_b64 exec, s[42:43]
    v_add_u32 v134, 2048, v134
    s_sub_u32 s96, s96, 1
    s_cmp_lg_u32 s96, 0
    s_cbranch_scc1 Lcp_14
    s_waitcnt lgkmcnt(0)
    v_mov_b32 v8, v130
    ds_read_b64 v[176:177], v8 offset:4480
    ds_read_b64 v[178:179], v8 offset:4512
    ds_read_b64 v[180:181], v8 offset:4352
    ds_read_b64 v[182:183], v8 offset:4384
    ds_read_b64 v[184:185], v8 offset:384
    ds_read_b64 v[186:187], v8 offset:416
    ds_read_b64 v[188:189], v8 offset:256
    ds_read_b64 v[190:191], v8 offset:288
    ds_read_b128 v[208:211], v132 offset:0
    ds_read_b128 v[212:215], v132 offset:1024
    ds_read_b128 v[216:219], v132 offset:2048
    ds_read_b128 v[220:223], v132 offset:3072
    s_waitcnt lgkmcnt(0)
    ds_read_b64 v[192:193], v8 offset:4224
    ds_read_b64 v[194:195], v8 offset:4256
    ds_read_b64 v[196:197], v8 offset:4096
    ds_read_b64 v[198:199], v8 offset:4128
    ds_read_b64 v[200:201], v8 offset:128
    ds_read_b64 v[202:203], v8 offset:160
    ds_read_b64 v[204:205], v8 offset:0
    ds_read_b64 v[206:207], v8 offset:32
    buffer_load_dwordx2 v[30:31], v2, s[12:15], s68 offen offset:0
    v_mfma_f32_16x16x32_bf16 v[144:147], v[176:179], v[208:211], v[144:147]
    v_mov_b32_dpp v48, v208 row_shr:1 row_mask:0xf bank_mask:0xf bound_ctrl:0
    v_mov_b32_dpp v49, v209 row_shr:1 row_mask:0xf bank_mask:0xf bound_ctrl:0
    v_mfma_f32_16x16x32_bf16 v[148:151], v[180:183], v[208:211], v[148:151]
    v_mov_b32_dpp v50, v210 row_shr:1 row_mask:0xf bank_mask:0xf bound_ctrl:0
    v_mov_b32_dpp v51, v211 row_shr:1 row_mask:0xf bank_mask:0xf bound_ctrl:0
    v_mfma_f32_16x16x32_bf16 v[152:155], v[176:179], v[212:215], v[152:155]
    v_mov_b32_dpp v52, v208 row_ror:1 row_mask:0xf bank_mask:0xf
    v_mov_b32_dpp v53, v209 row_ror:1 row_mask:0xf bank_mask:0xf
    v_mfma_f32_16x16x32_bf16 v[156:159], v[180:183], v[212:215], v[156:159]
    v_mov_b32_dpp v54, v210 row_ror:1 row_mask:0xf bank_mask:0xf
    v_mov_b32_dpp v55, v211 row_ror:1 row_mask:0xf bank_mask:0xf
    v_mfma_f32_16x16x32_bf16 v[160:163], v[176:179], v[216:219], v[160:163]
    v_mov_b32_dpp v52, v212 row_shr:1 row_mask:0xf bank_mask:0xf
    v_mov_b32_dpp v53, v213 row_shr:1 row_mask:0xf bank_mask:0xf
    v_mfma_f32_16x16x32_bf16 v[164:167], v[180:183], v[216:219], v[164:167]
    v_mov_b32_dpp v54, v214 row_shr:1 row_mask:0xf bank_mask:0xf
    v_mov_b32_dpp v55, v215 row_shr:1 row_mask:0xf bank_mask:0xf
    v_mfma_f32_16x16x32_bf16 v[168:171], v[176:179], v[220:223], v[168:171]
    v_mov_b32_dpp v56, v212 row_ror:1 row_mask:0xf bank_mask:0xf
    v_mov_b32_dpp v57, v213 row_ror:1 row_mask:0xf bank_mask:0xf
    v_mfma_f32_16x16x32_bf16 v[172:175], v[180:183], v[220:223], v[172:175]
    v_mov_b32_dpp v58, v214 row_ror:1 row_mask:0xf bank_mask:0xf
    v_mov_b32_dpp v59, v215 row_ror:1 row_mask:0xf bank_mask:0xf
    v_mfma_f32_16x16x32_bf16 v[152:155], v[184:187], v[208:211], v[152:155]
    v_mov_b32_dpp v56, v216 row_shr:1 row_mask:0xf bank_mask:0xf
    v_mov_b32_dpp v57, v217 row_shr:1 row_mask:0xf bank_mask:0xf
    v_mfma_f32_16x16x32_bf16 v[156:159], v[188:191], v[208:211], v[156:159]
    v_mov_b32_dpp v58, v218 row_shr:1 row_mask:0xf bank_mask:0xf
    v_mov_b32_dpp v59, v219 row_shr:1 row_mask:0xf bank_mask:0xf
    v_mfma_f32_16x16x32_bf16 v[160:163], v[184:187], v[212:215], v[160:163]
    v_mov_b32_dpp v60, v216 row_ror:1 row_mask:0xf bank_mask:0xf
    v_mov_b32_dpp v61, v217 row_ror:1 row_mask:0xf bank_mask:0xf
    v_mfma_f32_16x16x32_bf16 v[164:167], v[188:191], v[212:215], v[164:167]
    v_mov_b32_dpp v62, v218 row_ror:1 row_mask:0xf bank_mask:0xf
    v_mov_b32_dpp v63, v219 row_ror:1 row_mask:0xf bank_mask:0xf
    v_mfma_f32_16x16x32_bf16 v[168:171], v[184:187], v[216:219], v[168:171]
    v_mov_b32_dpp v60, v220 row_shr:1 row_mask:0xf bank_mask:0xf
    v_mov_b32_dpp v61, v221 row_shr:1 row_mask:0xf bank_mask:0xf
    v_mfma_f32_16x16x32_bf16 v[172:175], v[188:191], v[216:219], v[172:175]
    v_mov_b32_dpp v62, v222 row_shr:1 row_mask:0xf bank_mask:0xf
    v_mov_b32_dpp v63, v223 row_shr:1 row_mask:0xf bank_mask:0xf
    v_subrev_u32 v8, 512, v8
    s_waitcnt lgkmcnt(0)
    ds_read_b64 v[176:177], v8 offset:4480
    ds_read_b64 v[178:179], v8 offset:4512
    ds_read_b64 v[180:181], v8 offset:4352
    ds_read_b64 v[182:183], v8 offset:4384
    ds_read_b64 v[184:185], v8 offset:384
    ds_read_b64 v[186:187], v8 offset:416
    ds_read_b64 v[188:189], v8 offset:256
    ds_read_b64 v[190:191], v8 offset:288
    v_mfma_f32_16x16x32_bf16 v[144:147], v[192:195], v[48:51], v[144:147]
    v_mov_b32_dpp v208, v48 row_shr:1 row_mask:0xf bank_mask:0xf bound_ctrl:0
    v_mov_b32_dpp v209, v49 row_shr:1 row_mask:0xf bank_mask:0xf bound_ctrl:0
    v_mfma_f32_16x16x32_bf16 v[148:151], v[196:199], v[48:51], v[148:151]
    v_mov_b32_dpp v210, v50 row_shr:1 row_mask:0xf bank_mask:0xf bound_ctrl:0
    v_mov_b32_dpp v211, v51 row_shr:1 row_mask:0xf bank_mask:0xf bound_ctrl:0
    v_mfma_f32_16x16x32_bf16 v[152:155], v[192:195], v[52:55], v[152:155]
    v_mov_b32_dpp v212, v48 row_ror:1 row_mask:0xf bank_mask:0xf
    v_mov_b32_dpp v213, v49 row_ror:1 row_mask:0xf bank_mask:0xf
    v_mfma_f32_16x16x32_bf16 v[156:159], v[196:199], v[52:55], v[156:159]
    v_mov_b32_dpp v214, v50 row_ror:1 row_mask:0xf bank_mask:0xf
    v_mov_b32_dpp v215, v51 row_ror:1 row_mask:0xf bank_mask:0xf
    v_mfma_f32_16x16x32_bf16 v[160:163], v[192:195], v[56:59], v[160:163]
    v_mov_b32_dpp v212, v52 row_shr:1 row_mask:0xf bank_mask:0xf
    v_mov_b32_dpp v213, v53 row_shr:1 row_mask:0xf bank_mask:0xf
    v_mfma_f32_16x16x32_bf16 v[164:167], v[196:199], v[56:59], v[164:167]
    v_mov_b32_dpp v214, v54 row_shr:1 row_mask:0xf bank_mask:0xf
    v_mov_b32_dpp v215, v55 row_shr:1 row_mask:0xf bank_mask:0xf
    v_mfma_f32_16x16x32_bf16 v[168:171], v[192:195], v[60:63], v[168:171]
    v_mov_b32_dpp v216, v52 row_ror:1 row_mask:0xf bank_mask:0xf
    v_mov_b32_dpp v217, v53 row_ror:1 row_mask:0xf bank_mask:0xf
    v_mfma_f32_16x16x32_bf16 v[172:175], v[196:199], v[60:63], v[172:175]
    v_mov_b32_dpp v218, v54 row_ror:1 row_mask:0xf bank_mask:0xf
    v_mov_b32_dpp v219, v55 row_ror:1 row_mask:0xf bank_mask:0xf
    v_mfma_f32_16x16x32_bf16 v[152:155], v[200:203], v[48:51], v[152:155]
    v_mov_b32_dpp v216, v56 row_shr:1 row_mask:0xf bank_mask:0xf
    v_mov_b32_dpp v217, v57 row_shr:1 row_mask:0xf bank_mask:0xf
    v_mfma_f32_16x16x32_bf16 v[156:159], v[204:207], v[48:51], v[156:159]
    v_mov_b32_dpp v218, v58 row_shr:1 row_mask:0xf bank_mask:0xf
    v_mov_b32_dpp v219, v59 row_shr:1 row_mask:0xf bank_mask:0xf
    v_mfma_f32_16x16x32_bf16 v[160:163], v[200:203], v[52:55], v[160:163]
    v_mov_b32_dpp v220, v56 row_ror:1 row_mask:0xf bank_mask:0xf
    v_mov_b32_dpp v221, v57 row_ror:1 row_mask:0xf bank_mask:0xf
    v_mfma_f32_16x16x32_bf16 v[164:167], v[204:207], v[52:55], v[164:167]
    v_mov_b32_dpp v222, v58 row_ror:1 row_mask:0xf bank_mask:0xf
    v_mov_b32_dpp v223, v59 row_ror:1 row_mask:0xf bank_mask:0xf
    v_mfma_f32_16x16x32_bf16 v[168:171], v[200:203], v[56:59], v[168:171]
    v_mov_b32_dpp v220, v60 row_shr:1 row_mask:0xf bank_mask:0xf
    v_mov_b32_dpp v221, v61 row_shr:1 row_mask:0xf bank_mask:0xf
    v_mfma_f32_16x16x32_bf16 v[172:175], v[204:207], v[56:59], v[172:175]
    v_mov_b32_dpp v222, v62 row_shr:1 row_mask:0xf bank_mask:0xf
    v_mov_b32_dpp v223, v63 row_shr:1 row_mask:0xf bank_mask:0xf
    s_waitcnt lgkmcnt(0)
    ds_read_b64 v[192:193], v8 offset:4224
    ds_read_b64 v[194:195], v8 offset:4256
    ds_read_b64 v[196:197], v8 offset:4096
    ds_read_b64 v[198:199], v8 offset:4128
    ds_read_b64 v[200:201], v8 offset:128
    ds_read_b64 v[202:203], v8 offset:160
    ds_read_b64 v[204:205], v8 offset:0
    ds_read_b64 v[206:207], v8 offset:32
    buffer_load_dwordx2 v[32:33], v2, s[12:15], s68 offen offset:2048
    v_mfma_f32_16x16x32_bf16 v[144:147], v[176:179], v[208:211], v[144:147]
    v_mov_b32_dpp v48, v208 row_shr:1 row_mask:0xf bank_mask:0xf bound_ctrl:0
    v_mov_b32_dpp v49, v209 row_shr:1 row_mask:0xf bank_mask:0xf bound_ctrl:0
    v_mfma_f32_16x16x32_bf16 v[148:151], v[180:183], v[208:211], v[148:151]
    v_mov_b32_dpp v50, v210 row_shr:1 row_mask:0xf bank_mask:0xf bound_ctrl:0
    v_mov_b32_dpp v51, v211 row_shr:1 row_mask:0xf bank_mask:0xf bound_ctrl:0
    v_mfma_f32_16x16x32_bf16 v[152:155], v[176:179], v[212:215], v[152:155]
    v_mov_b32_dpp v52, v208 row_ror:1 row_mask:0xf bank_mask:0xf
    v_mov_b32_dpp v53, v209 row_ror:1 row_mask:0xf bank_mask:0xf
    v_mfma_f32_16x16x32_bf16 v[156:159], v[180:183], v[212:215], v[156:159]
    v_mov_b32_dpp v54, v210 row_ror:1 row_mask:0xf bank_mask:0xf
    v_mov_b32_dpp v55, v211 row_ror:1 row_mask:0xf bank_mask:0xf
    v_mfma_f32_16x16x32_bf16 v[160:163], v[176:179], v[216:219], v[160:163]
    v_mov_b32_dpp v52, v212 row_shr:1 row_mask:0xf bank_mask:0xf
    v_mov_b32_dpp v53, v213 row_shr:1 row_mask:0xf bank_mask:0xf
    v_mfma_f32_16x16x32_bf16 v[164:167], v[180:183], v[216:219], v[164:167]
    v_mov_b32_dpp v54, v214 row_shr:1 row_mask:0xf bank_mask:0xf
    v_mov_b32_dpp v55, v215 row_shr:1 row_mask:0xf bank_mask:0xf
    v_mfma_f32_16x16x32_bf16 v[168:171], v[176:179], v[220:223], v[168:171]
    v_mov_b32_dpp v56, v212 row_ror:1 row_mask:0xf bank_mask:0xf
    v_mov_b32_dpp v57, v213 row_ror:1 row_mask:0xf bank_mask:0xf
    v_mfma_f32_16x16x32_bf16 v[172:175], v[180:183], v[220:223], v[172:175]
    v_mov_b32_dpp v58, v214 row_ror:1 row_mask:0xf bank_mask:0xf
    v_mov_b32_dpp v59, v215 row_ror:1 row_mask:0xf bank_mask:0xf
    v_mfma_f32_16x16x32_bf16 v[152:155], v[184:187], v[208:211], v[152:155]
    v_mov_b32_dpp v56, v216 row_shr:1 row_mask:0xf bank_mask:0xf
    v_mov_b32_dpp v57, v217 row_shr:1 row_mask:0xf bank_mask:0xf
    v_mfma_f32_16x16x32_bf16 v[156:159], v[188:191], v[208:211], v[156:159]
    v_mov_b32_dpp v58, v218 row_shr:1 row_mask:0xf bank_mask:0xf
    v_mov_b32_dpp v59, v219 row_shr:1 row_mask:0xf bank_mask:0xf
    v_mfma_f32_16x16x32_bf16 v[160:163], v[184:187], v[212:215], v[160:163]
    v_mov_b32_dpp v60, v216 row_ror:1 row_mask:0xf bank_mask:0xf
    v_mov_b32_dpp v61, v217 row_ror:1 row_mask:0xf bank_mask:0xf
    v_mfma_f32_16x16x32_bf16 v[164:167], v[188:191], v[212:215], v[164:167]
    v_mov_b32_dpp v62, v218 row_ror:1 row_mask:0xf bank_mask:0xf
    v_mov_b32_dpp v63, v219 row_ror:1 row_mask:0xf bank_mask:0xf
    v_mfma_f32_16x16x32_bf16 v[168:171], v[184:187], v[216:219], v[168:171]
    v_mov_b32_dpp v60, v220 row_shr:1 row_mask:0xf bank_mask:0xf
    v_mov_b32_dpp v61, v221 row_shr:1 row_mask:0xf bank_mask:0xf
    v_mfma_f32_16x16x32_bf16 v[172:175], v[188:191], v[216:219], v[172:175]
    v_mov_b32_dpp v62, v222 row_shr:1 row_mask:0xf bank_mask:0xf
    v_mov_b32_dpp v63, v223 row_shr:1 row_mask:0xf bank_mask:0xf
    v_subrev_u32 v8, 512, v8
    s_waitcnt lgkmcnt(0)
    ds_read_b64 v[176:177], v8 offset:4480
    ds_read_b64 v[178:179], v8 offset:4512
    ds_read_b64 v[180:181], v8 offset:4352
    ds_read_b64 v[182:183], v8 offset:4384
    ds_read_b64 v[184:185], v8 offset:384
    ds_read_b64 v[186:187], v8 offset:416
    ds_read_b64 v[188:189], v8 offset:256
    ds_read_b64 v[190:191], v8 offset:288
    v_mfma_f32_16x16x32_bf16 v[144:147], v[192:195], v[48:51], v[144:147]
    v_mov_b32_dpp v208, v48 row_shr:1 row_mask:0xf bank_mask:0xf bound_ctrl:0
    v_mov_b32_dpp v209, v49 row_shr:1 row_mask:0xf bank_mask:0xf bound_ctrl:0
    v_mfma_f32_16x16x32_bf16 v[148:151], v[196:199], v[48:51], v[148:151]
    v_mov_b32_dpp v210, v50 row_shr:1 row_mask:0xf bank_mask:0xf bound_ctrl:0
    v_mov_b32_dpp v211, v51 row_shr:1 row_mask:0xf bank_mask:0xf bound_ctrl:0
    v_mfma_f32_16x16x32_bf16 v[152:155], v[192:195], v[52:55], v[152:155]
    v_mov_b32_dpp v212, v48 row_ror:1 row_mask:0xf bank_mask:0xf
    v_mov_b32_dpp v213, v49 row_ror:1 row_mask:0xf bank_mask:0xf
    v_mfma_f32_16x16x32_bf16 v[156:159], v[196:199], v[52:55], v[156:159]
    v_mov_b32_dpp v214, v50 row_ror:1 row_mask:0xf bank_mask:0xf
    v_mov_b32_dpp v215, v51 row_ror:1 row_mask:0xf bank_mask:0xf
    v_mfma_f32_16x16x32_bf16 v[160:163], v[192:195], v[56:59], v[160:163]
    v_mov_b32_dpp v212, v52 row_shr:1 row_mask:0xf bank_mask:0xf
    v_mov_b32_dpp v213, v53 row_shr:1 row_mask:0xf bank_mask:0xf
    v_mfma_f32_16x16x32_bf16 v[164:167], v[196:199], v[56:59], v[164:167]
    v_mov_b32_dpp v214, v54 row_shr:1 row_mask:0xf bank_mask:0xf
    v_mov_b32_dpp v215, v55 row_shr:1 row_mask:0xf bank_mask:0xf
    v_mfma_f32_16x16x32_bf16 v[168:171], v[192:195], v[60:63], v[168:171]
    v_mov_b32_dpp v216, v52 row_ror:1 row_mask:0xf bank_mask:0xf
    v_mov_b32_dpp v217, v53 row_ror:1 row_mask:0xf bank_mask:0xf
    v_mfma_f32_16x16x32_bf16 v[172:175], v[196:199], v[60:63], v[172:175]
    v_mov_b32_dpp v218, v54 row_ror:1 row_mask:0xf bank_mask:0xf
    v_mov_b32_dpp v219, v55 row_ror:1 row_mask:0xf bank_mask:0xf
    v_mfma_f32_16x16x32_bf16 v[152:155], v[200:203], v[48:51], v[152:155]
    v_mov_b32_dpp v216, v56 row_shr:1 row_mask:0xf bank_mask:0xf
    v_mov_b32_dpp v217, v57 row_shr:1 row_mask:0xf bank_mask:0xf
    v_mfma_f32_16x16x32_bf16 v[156:159], v[204:207], v[48:51], v[156:159]
    v_mov_b32_dpp v218, v58 row_shr:1 row_mask:0xf bank_mask:0xf
    v_mov_b32_dpp v219, v59 row_shr:1 row_mask:0xf bank_mask:0xf
    v_mfma_f32_16x16x32_bf16 v[160:163], v[200:203], v[52:55], v[160:163]
    v_mov_b32_dpp v220, v56 row_ror:1 row_mask:0xf bank_mask:0xf
    v_mov_b32_dpp v221, v57 row_ror:1 row_mask:0xf bank_mask:0xf
    v_mfma_f32_16x16x32_bf16 v[164:167], v[204:207], v[52:55], v[164:167]
    v_mov_b32_dpp v222, v58 row_ror:1 row_mask:0xf bank_mask:0xf
    v_mov_b32_dpp v223, v59 row_ror:1 row_mask:0xf bank_mask:0xf
    v_mfma_f32_16x16x32_bf16 v[168:171], v[200:203], v[56:59], v[168:171]
    v_mov_b32_dpp v220, v60 row_shr:1 row_mask:0xf bank_mask:0xf
    v_mov_b32_dpp v221, v61 row_shr:1 row_mask:0xf bank_mask:0xf
    v_mfma_f32_16x16x32_bf16 v[172:175], v[204:207], v[56:59], v[172:175]
    v_mov_b32_dpp v222, v62 row_shr:1 row_mask:0xf bank_mask:0xf
    v_mov_b32_dpp v223, v63 row_shr:1 row_mask:0xf bank_mask:0xf
    s_waitcnt lgkmcnt(0)
    ds_read_b64 v[192:193], v8 offset:4224
    ds_read_b64 v[194:195], v8 offset:4256
    ds_read_b64 v[196:197], v8 offset:4096
    ds_read_b64 v[198:199], v8 offset:4128
    ds_read_b64 v[200:201], v8 offset:128
    ds_read_b64 v[202:203], v8 offset:160
    ds_read_b64 v[204:205], v8 offset:0
    ds_read_b64 v[206:207], v8 offset:32
    buffer_load_dwordx2 v[34:35], v2, s[12:15], s69 offen offset:0
    v_mfma_f32_16x16x32_bf16 v[144:147], v[176:179], v[208:211], v[144:147]
    v_mov_b32_dpp v48, v208 row_shr:1 row_mask:0xf bank_mask:0xf bound_ctrl:0
    v_mov_b32_dpp v49, v209 row_shr:1 row_mask:0xf bank_mask:0xf bound_ctrl:0
    v_mfma_f32_16x16x32_bf16 v[148:151], v[180:183], v[208:211], v[148:151]
    v_mov_b32_dpp v50, v210 row_shr:1 row_mask:0xf bank_mask:0xf bound_ctrl:0
    v_mov_b32_dpp v51, v211 row_shr:1 row_mask:0xf bank_mask:0xf bound_ctrl:0
    v_mfma_f32_16x16x32_bf16 v[152:155], v[176:179], v[212:215], v[152:155]
    v_mov_b32_dpp v52, v208 row_ror:1 row_mask:0xf bank_mask:0xf
    v_mov_b32_dpp v53, v209 row_ror:1 row_mask:0xf bank_mask:0xf
    v_mfma_f32_16x16x32_bf16 v[156:159], v[180:183], v[212:215], v[156:159]
    v_mov_b32_dpp v54, v210 row_ror:1 row_mask:0xf bank_mask:0xf
    v_mov_b32_dpp v55, v211 row_ror:1 row_mask:0xf bank_mask:0xf
    v_mfma_f32_16x16x32_bf16 v[160:163], v[176:179], v[216:219], v[160:163]
    v_mov_b32_dpp v52, v212 row_shr:1 row_mask:0xf bank_mask:0xf
    v_mov_b32_dpp v53, v213 row_shr:1 row_mask:0xf bank_mask:0xf
    v_mfma_f32_16x16x32_bf16 v[164:167], v[180:183], v[216:219], v[164:167]
    v_mov_b32_dpp v54, v214 row_shr:1 row_mask:0xf bank_mask:0xf
    v_mov_b32_dpp v55, v215 row_shr:1 row_mask:0xf bank_mask:0xf
    v_mfma_f32_16x16x32_bf16 v[168:171], v[176:179], v[220:223], v[168:171]
    v_mov_b32_dpp v56, v212 row_ror:1 row_mask:0xf bank_mask:0xf
    v_mov_b32_dpp v57, v213 row_ror:1 row_mask:0xf bank_mask:0xf
    v_mfma_f32_16x16x32_bf16 v[172:175], v[180:183], v[220:223], v[172:175]
    v_mov_b32_dpp v58, v214 row_ror:1 row_mask:0xf bank_mask:0xf
    v_mov_b32_dpp v59, v215 row_ror:1 row_mask:0xf bank_mask:0xf
    v_mfma_f32_16x16x32_bf16 v[152:155], v[184:187], v[208:211], v[152:155]
    v_mov_b32_dpp v56, v216 row_shr:1 row_mask:0xf bank_mask:0xf
    v_mov_b32_dpp v57, v217 row_shr:1 row_mask:0xf bank_mask:0xf
    v_mfma_f32_16x16x32_bf16 v[156:159], v[188:191], v[208:211], v[156:159]
    v_mov_b32_dpp v58, v218 row_shr:1 row_mask:0xf bank_mask:0xf
    v_mov_b32_dpp v59, v219 row_shr:1 row_mask:0xf bank_mask:0xf
    v_mfma_f32_16x16x32_bf16 v[160:163], v[184:187], v[212:215], v[160:163]
    v_mov_b32_dpp v60, v216 row_ror:1 row_mask:0xf bank_mask:0xf
    v_mov_b32_dpp v61, v217 row_ror:1 row_mask:0xf bank_mask:0xf
    v_mfma_f32_16x16x32_bf16 v[164:167], v[188:191], v[212:215], v[164:167]
    v_mov_b32_dpp v62, v218 row_ror:1 row_mask:0xf bank_mask:0xf
    v_mov_b32_dpp v63, v219 row_ror:1 row_mask:0xf bank_mask:0xf
    v_mfma_f32_16x16x32_bf16 v[168:171], v[184:187], v[216:219], v[168:171]
    v_mov_b32_dpp v60, v220 row_shr:1 row_mask:0xf bank_mask:0xf
    v_mov_b32_dpp v61, v221 row_shr:1 row_mask:0xf bank_mask:0xf
    v_mfma_f32_16x16x32_bf16 v[172:175], v[188:191], v[216:219], v[172:175]
    v_mov_b32_dpp v62, v222 row_shr:1 row_mask:0xf bank_mask:0xf
    v_mov_b32_dpp v63, v223 row_shr:1 row_mask:0xf bank_mask:0xf
    v_subrev_u32 v8, 512, v8
    s_waitcnt lgkmcnt(0)
    ds_read_b64 v[176:177], v8 offset:4480
    ds_read_b64 v[178:179], v8 offset:4512
    ds_read_b64 v[180:181], v8 offset:4352
    ds_read_b64 v[182:183], v8 offset:4384
    ds_read_b64 v[184:185], v8 offset:384
    ds_read_b64 v[186:187], v8 offset:416
    ds_read_b64 v[188:189], v8 offset:256
    ds_read_b64 v[190:191], v8 offset:288
    v_mfma_f32_16x16x32_bf16 v[144:147], v[192:195], v[48:51], v[144:147]
    v_mov_b32_dpp v208, v48 row_shr:1 row_mask:0xf bank_mask:0xf bound_ctrl:0
    v_mov_b32_dpp v209, v49 row_shr:1 row_mask:0xf bank_mask:0xf bound_ctrl:0
    v_mfma_f32_16x16x32_bf16 v[148:151], v[196:199], v[48:51], v[148:151]
    v_mov_b32_dpp v210, v50 row_shr:1 row_mask:0xf bank_mask:0xf bound_ctrl:0
    v_mov_b32_dpp v211, v51 row_shr:1 row_mask:0xf bank_mask:0xf bound_ctrl:0
    v_mfma_f32_16x16x32_bf16 v[152:155], v[192:195], v[52:55], v[152:155]
    v_mov_b32_dpp v212, v48 row_ror:1 row_mask:0xf bank_mask:0xf
    v_mov_b32_dpp v213, v49 row_ror:1 row_mask:0xf bank_mask:0xf
    v_mfma_f32_16x16x32_bf16 v[156:159], v[196:199], v[52:55], v[156:159]
    v_mov_b32_dpp v214, v50 row_ror:1 row_mask:0xf bank_mask:0xf
    v_mov_b32_dpp v215, v51 row_ror:1 row_mask:0xf bank_mask:0xf
    v_mfma_f32_16x16x32_bf16 v[160:163], v[192:195], v[56:59], v[160:163]
    v_mov_b32_dpp v212, v52 row_shr:1 row_mask:0xf bank_mask:0xf
    v_mov_b32_dpp v213, v53 row_shr:1 row_mask:0xf bank_mask:0xf
    v_mfma_f32_16x16x32_bf16 v[164:167], v[196:199], v[56:59], v[164:167]
    v_mov_b32_dpp v214, v54 row_shr:1 row_mask:0xf bank_mask:0xf
    v_mov_b32_dpp v215, v55 row_shr:1 row_mask:0xf bank_mask:0xf
    v_mfma_f32_16x16x32_bf16 v[168:171], v[192:195], v[60:63], v[168:171]
    v_mov_b32_dpp v216, v52 row_ror:1 row_mask:0xf bank_mask:0xf
    v_mov_b32_dpp v217, v53 row_ror:1 row_mask:0xf bank_mask:0xf
    v_mfma_f32_16x16x32_bf16 v[172:175], v[196:199], v[60:63], v[172:175]
    v_mov_b32_dpp v218, v54 row_ror:1 row_mask:0xf bank_mask:0xf
    v_mov_b32_dpp v219, v55 row_ror:1 row_mask:0xf bank_mask:0xf
    v_mfma_f32_16x16x32_bf16 v[152:155], v[200:203], v[48:51], v[152:155]
    v_mov_b32_dpp v216, v56 row_shr:1 row_mask:0xf bank_mask:0xf
    v_mov_b32_dpp v217, v57 row_shr:1 row_mask:0xf bank_mask:0xf
    v_mfma_f32_16x16x32_bf16 v[156:159], v[204:207], v[48:51], v[156:159]
    v_mov_b32_dpp v218, v58 row_shr:1 row_mask:0xf bank_mask:0xf
    v_mov_b32_dpp v219, v59 row_shr:1 row_mask:0xf bank_mask:0xf
    v_mfma_f32_16x16x32_bf16 v[160:163], v[200:203], v[52:55], v[160:163]
    v_mov_b32_dpp v220, v56 row_ror:1 row_mask:0xf bank_mask:0xf
    v_mov_b32_dpp v221, v57 row_ror:1 row_mask:0xf bank_mask:0xf
    v_mfma_f32_16x16x32_bf16 v[164:167], v[204:207], v[52:55], v[164:167]
    v_mov_b32_dpp v222, v58 row_ror:1 row_mask:0xf bank_mask:0xf
    v_mov_b32_dpp v223, v59 row_ror:1 row_mask:0xf bank_mask:0xf
    v_mfma_f32_16x16x32_bf16 v[168:171], v[200:203], v[56:59], v[168:171]
    v_mov_b32_dpp v220, v60 row_shr:1 row_mask:0xf bank_mask:0xf
    v_mov_b32_dpp v221, v61 row_shr:1 row_mask:0xf bank_mask:0xf
    v_mfma_f32_16x16x32_bf16 v[172:175], v[204:207], v[56:59], v[172:175]
    v_mov_b32_dpp v222, v62 row_shr:1 row_mask:0xf bank_mask:0xf
    v_mov_b32_dpp v223, v63 row_shr:1 row_mask:0xf bank_mask:0xf
    s_waitcnt lgkmcnt(0)
    ds_read_b64 v[192:193], v8 offset:4224
    ds_read_b64 v[194:195], v8 offset:4256
    ds_read_b64 v[196:197], v8 offset:4096
    ds_read_b64 v[198:199], v8 offset:4128
    ds_read_b64 v[200:201], v8 offset:128
    ds_read_b64 v[202:203], v8 offset:160
    ds_read_b64 v[204:205], v8 offset:0
    ds_read_b64 v[206:207], v8 offset:32
    buffer_load_dwordx2 v[36:37], v2, s[12:15], s69 offen offset:2048
    v_mfma_f32_16x16x32_bf16 v[144:147], v[176:179], v[208:211], v[144:147]
    v_mov_b32_dpp v48, v208 row_shr:1 row_mask:0xf bank_mask:0xf bound_ctrl:0
    v_mov_b32_dpp v49, v209 row_shr:1 row_mask:0xf bank_mask:0xf bound_ctrl:0
    v_mfma_f32_16x16x32_bf16 v[148:151], v[180:183], v[208:211], v[148:151]
    v_mov_b32_dpp v50, v210 row_shr:1 row_mask:0xf bank_mask:0xf bound_ctrl:0
    v_mov_b32_dpp v51, v211 row_shr:1 row_mask:0xf bank_mask:0xf bound_ctrl:0
    v_mfma_f32_16x16x32_bf16 v[152:155], v[176:179], v[212:215], v[152:155]
    v_mov_b32_dpp v52, v208 row_ror:1 row_mask:0xf bank_mask:0xf
    v_mov_b32_dpp v53, v209 row_ror:1 row_mask:0xf bank_mask:0xf
    v_mfma_f32_16x16x32_bf16 v[156:159], v[180:183], v[212:215], v[156:159]
    v_mov_b32_dpp v54, v210 row_ror:1 row_mask:0xf bank_mask:0xf
    v_mov_b32_dpp v55, v211 row_ror:1 row_mask:0xf bank_mask:0xf
    v_mfma_f32_16x16x32_bf16 v[160:163], v[176:179], v[216:219], v[160:163]
    v_mov_b32_dpp v52, v212 row_shr:1 row_mask:0xf bank_mask:0xf
    v_mov_b32_dpp v53, v213 row_shr:1 row_mask:0xf bank_mask:0xf
    v_mfma_f32_16x16x32_bf16 v[164:167], v[180:183], v[216:219], v[164:167]
    v_mov_b32_dpp v54, v214 row_shr:1 row_mask:0xf bank_mask:0xf
    v_mov_b32_dpp v55, v215 row_shr:1 row_mask:0xf bank_mask:0xf
    v_mfma_f32_16x16x32_bf16 v[168:171], v[176:179], v[220:223], v[168:171]
    v_mov_b32_dpp v56, v212 row_ror:1 row_mask:0xf bank_mask:0xf
    v_mov_b32_dpp v57, v213 row_ror:1 row_mask:0xf bank_mask:0xf
    v_mfma_f32_16x16x32_bf16 v[172:175], v[180:183], v[220:223], v[172:175]
    v_mov_b32_dpp v58, v214 row_ror:1 row_mask:0xf bank_mask:0xf
    v_mov_b32_dpp v59, v215 row_ror:1 row_mask:0xf bank_mask:0xf
    v_mfma_f32_16x16x32_bf16 v[152:155], v[184:187], v[208:211], v[152:155]
    v_mov_b32_dpp v56, v216 row_shr:1 row_mask:0xf bank_mask:0xf
    v_mov_b32_dpp v57, v217 row_shr:1 row_mask:0xf bank_mask:0xf
    v_mfma_f32_16x16x32_bf16 v[156:159], v[188:191], v[208:211], v[156:159]
    v_mov_b32_dpp v58, v218 row_shr:1 row_mask:0xf bank_mask:0xf
    v_mov_b32_dpp v59, v219 row_shr:1 row_mask:0xf bank_mask:0xf
    v_mfma_f32_16x16x32_bf16 v[160:163], v[184:187], v[212:215], v[160:163]
    v_mov_b32_dpp v60, v216 row_ror:1 row_mask:0xf bank_mask:0xf
    v_mov_b32_dpp v61, v217 row_ror:1 row_mask:0xf bank_mask:0xf
    v_mfma_f32_16x16x32_bf16 v[164:167], v[188:191], v[212:215], v[164:167]
    v_mov_b32_dpp v62, v218 row_ror:1 row_mask:0xf bank_mask:0xf
    v_mov_b32_dpp v63, v219 row_ror:1 row_mask:0xf bank_mask:0xf
    v_mfma_f32_16x16x32_bf16 v[168:171], v[184:187], v[216:219], v[168:171]
    v_mov_b32_dpp v60, v220 row_shr:1 row_mask:0xf bank_mask:0xf
    v_mov_b32_dpp v61, v221 row_shr:1 row_mask:0xf bank_mask:0xf
    v_mfma_f32_16x16x32_bf16 v[172:175], v[188:191], v[216:219], v[172:175]
    v_mov_b32_dpp v62, v222 row_shr:1 row_mask:0xf bank_mask:0xf
    v_mov_b32_dpp v63, v223 row_shr:1 row_mask:0xf bank_mask:0xf
    v_subrev_u32 v8, 512, v8
    s_waitcnt lgkmcnt(0)
    ds_read_b64 v[176:177], v8 offset:4480
    ds_read_b64 v[178:179], v8 offset:4512
    ds_read_b64 v[180:181], v8 offset:4352
    ds_read_b64 v[182:183], v8 offset:4384
    ds_read_b64 v[184:185], v8 offset:384
    ds_read_b64 v[186:187], v8 offset:416
    ds_read_b64 v[188:189], v8 offset:256
    ds_read_b64 v[190:191], v8 offset:288
    v_mfma_f32_16x16x32_bf16 v[144:147], v[192:195], v[48:51], v[144:147]
    v_mov_b32_dpp v208, v48 row_shr:1 row_mask:0xf bank_mask:0xf bound_ctrl:0
    v_mov_b32_dpp v209, v49 row_shr:1 row_mask:0xf bank_mask:0xf bound_ctrl:0
    v_mfma_f32_16x16x32_bf16 v[148:151], v[196:199], v[48:51], v[148:151]
    v_mov_b32_dpp v210, v50 row_shr:1 row_mask:0xf bank_mask:0xf bound_ctrl:0
    v_mov_b32_dpp v211, v51 row_shr:1 row_mask:0xf bank_mask:0xf bound_ctrl:0
    v_mfma_f32_16x16x32_bf16 v[152:155], v[192:195], v[52:55], v[152:155]
    v_mov_b32_dpp v212, v48 row_ror:1 row_mask:0xf bank_mask:0xf
    v_mov_b32_dpp v213, v49 row_ror:1 row_mask:0xf bank_mask:0xf
    v_mfma_f32_16x16x32_bf16 v[156:159], v[196:199], v[52:55], v[156:159]
    v_mov_b32_dpp v214, v50 row_ror:1 row_mask:0xf bank_mask:0xf
    v_mov_b32_dpp v215, v51 row_ror:1 row_mask:0xf bank_mask:0xf
    v_mfma_f32_16x16x32_bf16 v[160:163], v[192:195], v[56:59], v[160:163]
    v_mov_b32_dpp v212, v52 row_shr:1 row_mask:0xf bank_mask:0xf
    v_mov_b32_dpp v213, v53 row_shr:1 row_mask:0xf bank_mask:0xf
    v_mfma_f32_16x16x32_bf16 v[164:167], v[196:199], v[56:59], v[164:167]
    v_mov_b32_dpp v214, v54 row_shr:1 row_mask:0xf bank_mask:0xf
    v_mov_b32_dpp v215, v55 row_shr:1 row_mask:0xf bank_mask:0xf
    v_mfma_f32_16x16x32_bf16 v[168:171], v[192:195], v[60:63], v[168:171]
    v_mov_b32_dpp v216, v52 row_ror:1 row_mask:0xf bank_mask:0xf
    v_mov_b32_dpp v217, v53 row_ror:1 row_mask:0xf bank_mask:0xf
    v_mfma_f32_16x16x32_bf16 v[172:175], v[196:199], v[60:63], v[172:175]
    v_mov_b32_dpp v218, v54 row_ror:1 row_mask:0xf bank_mask:0xf
    v_mov_b32_dpp v219, v55 row_ror:1 row_mask:0xf bank_mask:0xf
    v_mfma_f32_16x16x32_bf16 v[152:155], v[200:203], v[48:51], v[152:155]
    v_mov_b32_dpp v216, v56 row_shr:1 row_mask:0xf bank_mask:0xf
    v_mov_b32_dpp v217, v57 row_shr:1 row_mask:0xf bank_mask:0xf
    v_mfma_f32_16x16x32_bf16 v[156:159], v[204:207], v[48:51], v[156:159]
    v_mov_b32_dpp v218, v58 row_shr:1 row_mask:0xf bank_mask:0xf
    v_mov_b32_dpp v219, v59 row_shr:1 row_mask:0xf bank_mask:0xf
    v_mfma_f32_16x16x32_bf16 v[160:163], v[200:203], v[52:55], v[160:163]
    v_mov_b32_dpp v220, v56 row_ror:1 row_mask:0xf bank_mask:0xf
    v_mov_b32_dpp v221, v57 row_ror:1 row_mask:0xf bank_mask:0xf
    v_mfma_f32_16x16x32_bf16 v[164:167], v[204:207], v[52:55], v[164:167]
    v_mov_b32_dpp v222, v58 row_ror:1 row_mask:0xf bank_mask:0xf
    v_mov_b32_dpp v223, v59 row_ror:1 row_mask:0xf bank_mask:0xf
    v_mfma_f32_16x16x32_bf16 v[168:171], v[200:203], v[56:59], v[168:171]
    v_mov_b32_dpp v220, v60 row_shr:1 row_mask:0xf bank_mask:0xf
    v_mov_b32_dpp v221, v61 row_shr:1 row_mask:0xf bank_mask:0xf
    v_mfma_f32_16x16x32_bf16 v[172:175], v[204:207], v[56:59], v[172:175]
    v_mov_b32_dpp v222, v62 row_shr:1 row_mask:0xf bank_mask:0xf
    v_mov_b32_dpp v223, v63 row_shr:1 row_mask:0xf bank_mask:0xf
    s_waitcnt lgkmcnt(0)
    ds_read_b64 v[192:193], v8 offset:4224
    ds_read_b64 v[194:195], v8 offset:4256
    ds_read_b64 v[196:197], v8 offset:4096
    ds_read_b64 v[198:199], v8 offset:4128
    ds_read_b64 v[200:201], v8 offset:128
    ds_read_b64 v[202:203], v8 offset:160
    ds_read_b64 v[204:205], v8 offset:0
    ds_read_b64 v[206:207], v8 offset:32
    buffer_load_dwordx2 v[38:39], v2, s[12:15], s70 offen offset:0
    v_mfma_f32_16x16x32_bf16 v[144:147], v[176:179], v[208:211], v[144:147]
    v_mov_b32_dpp v48, v208 row_shr:1 row_mask:0xf bank_mask:0xf bound_ctrl:0
    v_mov_b32_dpp v49, v209 row_shr:1 row_mask:0xf bank_mask:0xf bound_ctrl:0
    v_mfma_f32_16x16x32_bf16 v[148:151], v[180:183], v[208:211], v[148:151]
    v_mov_b32_dpp v50, v210 row_shr:1 row_mask:0xf bank_mask:0xf bound_ctrl:0
    v_mov_b32_dpp v51, v211 row_shr:1 row_mask:0xf bank_mask:0xf bound_ctrl:0
    v_mfma_f32_16x16x32_bf16 v[152:155], v[176:179], v[212:215], v[152:155]
    v_mov_b32_dpp v52, v208 row_ror:1 row_mask:0xf bank_mask:0xf
    v_mov_b32_dpp v53, v209 row_ror:1 row_mask:0xf bank_mask:0xf
    v_mfma_f32_16x16x32_bf16 v[156:159], v[180:183], v[212:215], v[156:159]
    v_mov_b32_dpp v54, v210 row_ror:1 row_mask:0xf bank_mask:0xf
    v_mov_b32_dpp v55, v211 row_ror:1 row_mask:0xf bank_mask:0xf
    v_mfma_f32_16x16x32_bf16 v[160:163], v[176:179], v[216:219], v[160:163]
    v_mov_b32_dpp v52, v212 row_shr:1 row_mask:0xf bank_mask:0xf
    v_mov_b32_dpp v53, v213 row_shr:1 row_mask:0xf bank_mask:0xf
    v_mfma_f32_16x16x32_bf16 v[164:167], v[180:183], v[216:219], v[164:167]
    v_mov_b32_dpp v54, v214 row_shr:1 row_mask:0xf bank_mask:0xf
    v_mov_b32_dpp v55, v215 row_shr:1 row_mask:0xf bank_mask:0xf
    v_mfma_f32_16x16x32_bf16 v[168:171], v[176:179], v[220:223], v[168:171]
    v_mov_b32_dpp v56, v212 row_ror:1 row_mask:0xf bank_mask:0xf
    v_mov_b32_dpp v57, v213 row_ror:1 row_mask:0xf bank_mask:0xf
    v_mfma_f32_16x16x32_bf16 v[172:175], v[180:183], v[220:223], v[172:175]
    v_mov_b32_dpp v58, v214 row_ror:1 row_mask:0xf bank_mask:0xf
    v_mov_b32_dpp v59, v215 row_ror:1 row_mask:0xf bank_mask:0xf
    v_mfma_f32_16x16x32_bf16 v[152:155], v[184:187], v[208:211], v[152:155]
    v_mov_b32_dpp v56, v216 row_shr:1 row_mask:0xf bank_mask:0xf
    v_mov_b32_dpp v57, v217 row_shr:1 row_mask:0xf bank_mask:0xf
    v_mfma_f32_16x16x32_bf16 v[156:159], v[188:191], v[208:211], v[156:159]
    v_mov_b32_dpp v58, v218 row_shr:1 row_mask:0xf bank_mask:0xf
    v_mov_b32_dpp v59, v219 row_shr:1 row_mask:0xf bank_mask:0xf
    v_mfma_f32_16x16x32_bf16 v[160:163], v[184:187], v[212:215], v[160:163]
    v_mov_b32_dpp v60, v216 row_ror:1 row_mask:0xf bank_mask:0xf
    v_mov_b32_dpp v61, v217 row_ror:1 row_mask:0xf bank_mask:0xf
    v_mfma_f32_16x16x32_bf16 v[164:167], v[188:191], v[212:215], v[164:167]
    v_mov_b32_dpp v62, v218 row_ror:1 row_mask:0xf bank_mask:0xf
    v_mov_b32_dpp v63, v219 row_ror:1 row_mask:0xf bank_mask:0xf
    v_mfma_f32_16x16x32_bf16 v[168:171], v[184:187], v[216:219], v[168:171]
    v_mov_b32_dpp v60, v220 row_shr:1 row_mask:0xf bank_mask:0xf
    v_mov_b32_dpp v61, v221 row_shr:1 row_mask:0xf bank_mask:0xf
    v_mfma_f32_16x16x32_bf16 v[172:175], v[188:191], v[216:219], v[172:175]
    v_mov_b32_dpp v62, v222 row_shr:1 row_mask:0xf bank_mask:0xf
    v_mov_b32_dpp v63, v223 row_shr:1 row_mask:0xf bank_mask:0xf
    v_subrev_u32 v8, 512, v8
    s_waitcnt lgkmcnt(0)
    ds_read_b64 v[176:177], v8 offset:4480
    ds_read_b64 v[178:179], v8 offset:4512
    ds_read_b64 v[180:181], v8 offset:4352
    ds_read_b64 v[182:183], v8 offset:4384
    ds_read_b64 v[184:185], v8 offset:384
    ds_read_b64 v[186:187], v8 offset:416
    ds_read_b64 v[188:189], v8 offset:256
    ds_read_b64 v[190:191], v8 offset:288
    v_mfma_f32_16x16x32_bf16 v[144:147], v[192:195], v[48:51], v[144:147]
    v_mov_b32_dpp v208, v48 row_shr:1 row_mask:0xf bank_mask:0xf bound_ctrl:0
    v_mov_b32_dpp v209, v49 row_shr:1 row_mask:0xf bank_mask:0xf bound_ctrl:0
    v_mfma_f32_16x16x32_bf16 v[148:151], v[196:199], v[48:51], v[148:151]
    v_mov_b32_dpp v210, v50 row_shr:1 row_mask:0xf bank_mask:0xf bound_ctrl:0
    v_mov_b32_dpp v211, v51 row_shr:1 row_mask:0xf bank_mask:0xf bound_ctrl:0
    v_mfma_f32_16x16x32_bf16 v[152:155], v[192:195], v[52:55], v[152:155]
    v_mov_b32_dpp v212, v48 row_ror:1 row_mask:0xf bank_mask:0xf
    v_mov_b32_dpp v213, v49 row_ror:1 row_mask:0xf bank_mask:0xf
    v_mfma_f32_16x16x32_bf16 v[156:159], v[196:199], v[52:55], v[156:159]
    v_mov_b32_dpp v214, v50 row_ror:1 row_mask:0xf bank_mask:0xf
    v_mov_b32_dpp v215, v51 row_ror:1 row_mask:0xf bank_mask:0xf
    v_mfma_f32_16x16x32_bf16 v[160:163], v[192:195], v[56:59], v[160:163]
    v_mov_b32_dpp v212, v52 row_shr:1 row_mask:0xf bank_mask:0xf
    v_mov_b32_dpp v213, v53 row_shr:1 row_mask:0xf bank_mask:0xf
    v_mfma_f32_16x16x32_bf16 v[164:167], v[196:199], v[56:59], v[164:167]
    v_mov_b32_dpp v214, v54 row_shr:1 row_mask:0xf bank_mask:0xf
    v_mov_b32_dpp v215, v55 row_shr:1 row_mask:0xf bank_mask:0xf
    v_mfma_f32_16x16x32_bf16 v[168:171], v[192:195], v[60:63], v[168:171]
    v_mov_b32_dpp v216, v52 row_ror:1 row_mask:0xf bank_mask:0xf
    v_mov_b32_dpp v217, v53 row_ror:1 row_mask:0xf bank_mask:0xf
    v_mfma_f32_16x16x32_bf16 v[172:175], v[196:199], v[60:63], v[172:175]
    v_mov_b32_dpp v218, v54 row_ror:1 row_mask:0xf bank_mask:0xf
    v_mov_b32_dpp v219, v55 row_ror:1 row_mask:0xf bank_mask:0xf
    v_mfma_f32_16x16x32_bf16 v[152:155], v[200:203], v[48:51], v[152:155]
    v_mov_b32_dpp v216, v56 row_shr:1 row_mask:0xf bank_mask:0xf
    v_mov_b32_dpp v217, v57 row_shr:1 row_mask:0xf bank_mask:0xf
    v_mfma_f32_16x16x32_bf16 v[156:159], v[204:207], v[48:51], v[156:159]
    v_mov_b32_dpp v218, v58 row_shr:1 row_mask:0xf bank_mask:0xf
    v_mov_b32_dpp v219, v59 row_shr:1 row_mask:0xf bank_mask:0xf
    v_mfma_f32_16x16x32_bf16 v[160:163], v[200:203], v[52:55], v[160:163]
    v_mov_b32_dpp v220, v56 row_ror:1 row_mask:0xf bank_mask:0xf
    v_mov_b32_dpp v221, v57 row_ror:1 row_mask:0xf bank_mask:0xf
    v_mfma_f32_16x16x32_bf16 v[164:167], v[204:207], v[52:55], v[164:167]
    v_mov_b32_dpp v222, v58 row_ror:1 row_mask:0xf bank_mask:0xf
    v_mov_b32_dpp v223, v59 row_ror:1 row_mask:0xf bank_mask:0xf
    v_mfma_f32_16x16x32_bf16 v[168:171], v[200:203], v[56:59], v[168:171]
    v_mov_b32_dpp v220, v60 row_shr:1 row_mask:0xf bank_mask:0xf
    v_mov_b32_dpp v221, v61 row_shr:1 row_mask:0xf bank_mask:0xf
    v_mfma_f32_16x16x32_bf16 v[172:175], v[204:207], v[56:59], v[172:175]
    v_mov_b32_dpp v222, v62 row_shr:1 row_mask:0xf bank_mask:0xf
    v_mov_b32_dpp v223, v63 row_shr:1 row_mask:0xf bank_mask:0xf
    s_waitcnt lgkmcnt(0)
    ds_read_b64 v[192:193], v8 offset:4224
    ds_read_b64 v[194:195], v8 offset:4256
    ds_read_b64 v[196:197], v8 offset:4096
    ds_read_b64 v[198:199], v8 offset:4128
    ds_read_b64 v[200:201], v8 offset:128
    ds_read_b64 v[202:203], v8 offset:160
    ds_read_b64 v[204:205], v8 offset:0
    ds_read_b64 v[206:207], v8 offset:32
    buffer_load_dwordx2 v[40:41], v2, s[12:15], s70 offen offset:2048
    v_mfma_f32_16x16x32_bf16 v[144:147], v[176:179], v[208:211], v[144:147]
    v_mov_b32_dpp v48, v208 row_shr:1 row_mask:0xf bank_mask:0xf bound_ctrl:0
    v_mov_b32_dpp v49, v209 row_shr:1 row_mask:0xf bank_mask:0xf bound_ctrl:0
    v_mfma_f32_16x16x32_bf16 v[148:151], v[180:183], v[208:211], v[148:151]
    v_mov_b32_dpp v50, v210 row_shr:1 row_mask:0xf bank_mask:0xf bound_ctrl:0
    v_mov_b32_dpp v51, v211 row_shr:1 row_mask:0xf bank_mask:0xf bound_ctrl:0
    v_mfma_f32_16x16x32_bf16 v[152:155], v[176:179], v[212:215], v[152:155]
    v_mov_b32_dpp v52, v208 row_ror:1 row_mask:0xf bank_mask:0xf
    v_mov_b32_dpp v53, v209 row_ror:1 row_mask:0xf bank_mask:0xf
    v_mfma_f32_16x16x32_bf16 v[156:159], v[180:183], v[212:215], v[156:159]
    v_mov_b32_dpp v54, v210 row_ror:1 row_mask:0xf bank_mask:0xf
    v_mov_b32_dpp v55, v211 row_ror:1 row_mask:0xf bank_mask:0xf
    v_mfma_f32_16x16x32_bf16 v[160:163], v[176:179], v[216:219], v[160:163]
    v_mov_b32_dpp v52, v212 row_shr:1 row_mask:0xf bank_mask:0xf
    v_mov_b32_dpp v53, v213 row_shr:1 row_mask:0xf bank_mask:0xf
    v_mfma_f32_16x16x32_bf16 v[164:167], v[180:183], v[216:219], v[164:167]
    v_mov_b32_dpp v54, v214 row_shr:1 row_mask:0xf bank_mask:0xf
    v_mov_b32_dpp v55, v215 row_shr:1 row_mask:0xf bank_mask:0xf
    v_mfma_f32_16x16x32_bf16 v[168:171], v[176:179], v[220:223], v[168:171]
    v_mov_b32_dpp v56, v212 row_ror:1 row_mask:0xf bank_mask:0xf
    v_mov_b32_dpp v57, v213 row_ror:1 row_mask:0xf bank_mask:0xf
    v_mfma_f32_16x16x32_bf16 v[172:175], v[180:183], v[220:223], v[172:175]
    v_mov_b32_dpp v58, v214 row_ror:1 row_mask:0xf bank_mask:0xf
    v_mov_b32_dpp v59, v215 row_ror:1 row_mask:0xf bank_mask:0xf
    v_mfma_f32_16x16x32_bf16 v[152:155], v[184:187], v[208:211], v[152:155]
    v_mov_b32_dpp v56, v216 row_shr:1 row_mask:0xf bank_mask:0xf
    v_mov_b32_dpp v57, v217 row_shr:1 row_mask:0xf bank_mask:0xf
    v_mfma_f32_16x16x32_bf16 v[156:159], v[188:191], v[208:211], v[156:159]
    v_mov_b32_dpp v58, v218 row_shr:1 row_mask:0xf bank_mask:0xf
    v_mov_b32_dpp v59, v219 row_shr:1 row_mask:0xf bank_mask:0xf
    v_mfma_f32_16x16x32_bf16 v[160:163], v[184:187], v[212:215], v[160:163]
    v_mov_b32_dpp v60, v216 row_ror:1 row_mask:0xf bank_mask:0xf
    v_mov_b32_dpp v61, v217 row_ror:1 row_mask:0xf bank_mask:0xf
    v_mfma_f32_16x16x32_bf16 v[164:167], v[188:191], v[212:215], v[164:167]
    v_mov_b32_dpp v62, v218 row_ror:1 row_mask:0xf bank_mask:0xf
    v_mov_b32_dpp v63, v219 row_ror:1 row_mask:0xf bank_mask:0xf
    v_mfma_f32_16x16x32_bf16 v[168:171], v[184:187], v[216:219], v[168:171]
    v_mov_b32_dpp v60, v220 row_shr:1 row_mask:0xf bank_mask:0xf
    v_mov_b32_dpp v61, v221 row_shr:1 row_mask:0xf bank_mask:0xf
    v_mfma_f32_16x16x32_bf16 v[172:175], v[188:191], v[216:219], v[172:175]
    v_mov_b32_dpp v62, v222 row_shr:1 row_mask:0xf bank_mask:0xf
    v_mov_b32_dpp v63, v223 row_shr:1 row_mask:0xf bank_mask:0xf
    v_subrev_u32 v8, 512, v8
    s_waitcnt lgkmcnt(0)
    ds_read_b64 v[176:177], v8 offset:4480
    ds_read_b64 v[178:179], v8 offset:4512
    ds_read_b64 v[180:181], v8 offset:4352
    ds_read_b64 v[182:183], v8 offset:4384
    ds_read_b64 v[184:185], v8 offset:384
    ds_read_b64 v[186:187], v8 offset:416
    ds_read_b64 v[188:189], v8 offset:256
    ds_read_b64 v[190:191], v8 offset:288
    v_mfma_f32_16x16x32_bf16 v[144:147], v[192:195], v[48:51], v[144:147]
    v_mov_b32_dpp v208, v48 row_shr:1 row_mask:0xf bank_mask:0xf bound_ctrl:0
    v_mov_b32_dpp v209, v49 row_shr:1 row_mask:0xf bank_mask:0xf bound_ctrl:0
    v_mfma_f32_16x16x32_bf16 v[148:151], v[196:199], v[48:51], v[148:151]
    v_mov_b32_dpp v210, v50 row_shr:1 row_mask:0xf bank_mask:0xf bound_ctrl:0
    v_mov_b32_dpp v211, v51 row_shr:1 row_mask:0xf bank_mask:0xf bound_ctrl:0
    v_mfma_f32_16x16x32_bf16 v[152:155], v[192:195], v[52:55], v[152:155]
    v_mov_b32_dpp v212, v48 row_ror:1 row_mask:0xf bank_mask:0xf
    v_mov_b32_dpp v213, v49 row_ror:1 row_mask:0xf bank_mask:0xf
    v_mfma_f32_16x16x32_bf16 v[156:159], v[196:199], v[52:55], v[156:159]
    v_mov_b32_dpp v214, v50 row_ror:1 row_mask:0xf bank_mask:0xf
    v_mov_b32_dpp v215, v51 row_ror:1 row_mask:0xf bank_mask:0xf
    v_mfma_f32_16x16x32_bf16 v[160:163], v[192:195], v[56:59], v[160:163]
    v_mov_b32_dpp v212, v52 row_shr:1 row_mask:0xf bank_mask:0xf
    v_mov_b32_dpp v213, v53 row_shr:1 row_mask:0xf bank_mask:0xf
    v_mfma_f32_16x16x32_bf16 v[164:167], v[196:199], v[56:59], v[164:167]
    v_mov_b32_dpp v214, v54 row_shr:1 row_mask:0xf bank_mask:0xf
    v_mov_b32_dpp v215, v55 row_shr:1 row_mask:0xf bank_mask:0xf
    v_mfma_f32_16x16x32_bf16 v[168:171], v[192:195], v[60:63], v[168:171]
    v_mov_b32_dpp v216, v52 row_ror:1 row_mask:0xf bank_mask:0xf
    v_mov_b32_dpp v217, v53 row_ror:1 row_mask:0xf bank_mask:0xf
    v_mfma_f32_16x16x32_bf16 v[172:175], v[196:199], v[60:63], v[172:175]
    v_mov_b32_dpp v218, v54 row_ror:1 row_mask:0xf bank_mask:0xf
    v_mov_b32_dpp v219, v55 row_ror:1 row_mask:0xf bank_mask:0xf
    v_mfma_f32_16x16x32_bf16 v[152:155], v[200:203], v[48:51], v[152:155]
    v_mov_b32_dpp v216, v56 row_shr:1 row_mask:0xf bank_mask:0xf
    v_mov_b32_dpp v217, v57 row_shr:1 row_mask:0xf bank_mask:0xf
    v_mfma_f32_16x16x32_bf16 v[156:159], v[204:207], v[48:51], v[156:159]
    v_mov_b32_dpp v218, v58 row_shr:1 row_mask:0xf bank_mask:0xf
    v_mov_b32_dpp v219, v59 row_shr:1 row_mask:0xf bank_mask:0xf
    v_mfma_f32_16x16x32_bf16 v[160:163], v[200:203], v[52:55], v[160:163]
    v_mov_b32_dpp v220, v56 row_ror:1 row_mask:0xf bank_mask:0xf
    v_mov_b32_dpp v221, v57 row_ror:1 row_mask:0xf bank_mask:0xf
    v_mfma_f32_16x16x32_bf16 v[164:167], v[204:207], v[52:55], v[164:167]
    v_mov_b32_dpp v222, v58 row_ror:1 row_mask:0xf bank_mask:0xf
    v_mov_b32_dpp v223, v59 row_ror:1 row_mask:0xf bank_mask:0xf
    v_mfma_f32_16x16x32_bf16 v[168:171], v[200:203], v[56:59], v[168:171]
    v_mov_b32_dpp v220, v60 row_shr:1 row_mask:0xf bank_mask:0xf
    v_mov_b32_dpp v221, v61 row_shr:1 row_mask:0xf bank_mask:0xf
    v_mfma_f32_16x16x32_bf16 v[172:175], v[204:207], v[56:59], v[172:175]
    v_mov_b32_dpp v222, v62 row_shr:1 row_mask:0xf bank_mask:0xf
    v_mov_b32_dpp v223, v63 row_shr:1 row_mask:0xf bank_mask:0xf
    s_waitcnt lgkmcnt(0)
    ds_read_b64 v[192:193], v8 offset:4224
    ds_read_b64 v[194:195], v8 offset:4256
    ds_read_b64 v[196:197], v8 offset:4096
    ds_read_b64 v[198:199], v8 offset:4128
    ds_read_b64 v[200:201], v8 offset:128
    ds_read_b64 v[202:203], v8 offset:160
    ds_read_b64 v[204:205], v8 offset:0
    ds_read_b64 v[206:207], v8 offset:32
    buffer_load_dwordx2 v[42:43], v2, s[12:15], s71 offen offset:0
    v_mfma_f32_16x16x32_bf16 v[144:147], v[176:179], v[208:211], v[144:147]
    v_mov_b32_dpp v48, v208 row_shr:1 row_mask:0xf bank_mask:0xf bound_ctrl:0
    v_mov_b32_dpp v49, v209 row_shr:1 row_mask:0xf bank_mask:0xf bound_ctrl:0
    v_mfma_f32_16x16x32_bf16 v[148:151], v[180:183], v[208:211], v[148:151]
    v_mov_b32_dpp v50, v210 row_shr:1 row_mask:0xf bank_mask:0xf bound_ctrl:0
    v_mov_b32_dpp v51, v211 row_shr:1 row_mask:0xf bank_mask:0xf bound_ctrl:0
    v_mfma_f32_16x16x32_bf16 v[152:155], v[176:179], v[212:215], v[152:155]
    v_mov_b32_dpp v52, v208 row_ror:1 row_mask:0xf bank_mask:0xf
    v_mov_b32_dpp v53, v209 row_ror:1 row_mask:0xf bank_mask:0xf
    v_mfma_f32_16x16x32_bf16 v[156:159], v[180:183], v[212:215], v[156:159]
    v_mov_b32_dpp v54, v210 row_ror:1 row_mask:0xf bank_mask:0xf
    v_mov_b32_dpp v55, v211 row_ror:1 row_mask:0xf bank_mask:0xf
    v_mfma_f32_16x16x32_bf16 v[160:163], v[176:179], v[216:219], v[160:163]
    v_mov_b32_dpp v52, v212 row_shr:1 row_mask:0xf bank_mask:0xf
    v_mov_b32_dpp v53, v213 row_shr:1 row_mask:0xf bank_mask:0xf
    v_mfma_f32_16x16x32_bf16 v[164:167], v[180:183], v[216:219], v[164:167]
    v_mov_b32_dpp v54, v214 row_shr:1 row_mask:0xf bank_mask:0xf
    v_mov_b32_dpp v55, v215 row_shr:1 row_mask:0xf bank_mask:0xf
    v_mfma_f32_16x16x32_bf16 v[168:171], v[176:179], v[220:223], v[168:171]
    v_mov_b32_dpp v56, v212 row_ror:1 row_mask:0xf bank_mask:0xf
    v_mov_b32_dpp v57, v213 row_ror:1 row_mask:0xf bank_mask:0xf
    v_mfma_f32_16x16x32_bf16 v[172:175], v[180:183], v[220:223], v[172:175]
    v_mov_b32_dpp v58, v214 row_ror:1 row_mask:0xf bank_mask:0xf
    v_mov_b32_dpp v59, v215 row_ror:1 row_mask:0xf bank_mask:0xf
    v_mfma_f32_16x16x32_bf16 v[152:155], v[184:187], v[208:211], v[152:155]
    v_mov_b32_dpp v56, v216 row_shr:1 row_mask:0xf bank_mask:0xf
    v_mov_b32_dpp v57, v217 row_shr:1 row_mask:0xf bank_mask:0xf
    v_mfma_f32_16x16x32_bf16 v[156:159], v[188:191], v[208:211], v[156:159]
    v_mov_b32_dpp v58, v218 row_shr:1 row_mask:0xf bank_mask:0xf
    v_mov_b32_dpp v59, v219 row_shr:1 row_mask:0xf bank_mask:0xf
    v_mfma_f32_16x16x32_bf16 v[160:163], v[184:187], v[212:215], v[160:163]
    v_mov_b32_dpp v60, v216 row_ror:1 row_mask:0xf bank_mask:0xf
    v_mov_b32_dpp v61, v217 row_ror:1 row_mask:0xf bank_mask:0xf
    v_mfma_f32_16x16x32_bf16 v[164:167], v[188:191], v[212:215], v[164:167]
    v_mov_b32_dpp v62, v218 row_ror:1 row_mask:0xf bank_mask:0xf
    v_mov_b32_dpp v63, v219 row_ror:1 row_mask:0xf bank_mask:0xf
    v_mfma_f32_16x16x32_bf16 v[168:171], v[184:187], v[216:219], v[168:171]
    v_mov_b32_dpp v60, v220 row_shr:1 row_mask:0xf bank_mask:0xf
    v_mov_b32_dpp v61, v221 row_shr:1 row_mask:0xf bank_mask:0xf
    v_mfma_f32_16x16x32_bf16 v[172:175], v[188:191], v[216:219], v[172:175]
    v_mov_b32_dpp v62, v222 row_shr:1 row_mask:0xf bank_mask:0xf
    v_mov_b32_dpp v63, v223 row_shr:1 row_mask:0xf bank_mask:0xf
    v_subrev_u32 v8, 512, v8
    s_waitcnt lgkmcnt(0)
    ds_read_b64 v[176:177], v8 offset:4480
    ds_read_b64 v[178:179], v8 offset:4512
    ds_read_b64 v[180:181], v8 offset:4352
    ds_read_b64 v[182:183], v8 offset:4384
    ds_read_b64 v[184:185], v8 offset:384
    ds_read_b64 v[186:187], v8 offset:416
    ds_read_b64 v[188:189], v8 offset:256
    ds_read_b64 v[190:191], v8 offset:288
    v_mfma_f32_16x16x32_bf16 v[144:147], v[192:195], v[48:51], v[144:147]
    v_mov_b32_dpp v208, v48 row_shr:1 row_mask:0xf bank_mask:0xf bound_ctrl:0
    v_mov_b32_dpp v209, v49 row_shr:1 row_mask:0xf bank_mask:0xf bound_ctrl:0
    v_mfma_f32_16x16x32_bf16 v[148:151], v[196:199], v[48:51], v[148:151]
    v_mov_b32_dpp v210, v50 row_shr:1 row_mask:0xf bank_mask:0xf bound_ctrl:0
    v_mov_b32_dpp v211, v51 row_shr:1 row_mask:0xf bank_mask:0xf bound_ctrl:0
    v_mfma_f32_16x16x32_bf16 v[152:155], v[192:195], v[52:55], v[152:155]
    v_mov_b32_dpp v212, v48 row_ror:1 row_mask:0xf bank_mask:0xf
    v_mov_b32_dpp v213, v49 row_ror:1 row_mask:0xf bank_mask:0xf
    v_mfma_f32_16x16x32_bf16 v[156:159], v[196:199], v[52:55], v[156:159]
    v_mov_b32_dpp v214, v50 row_ror:1 row_mask:0xf bank_mask:0xf
    v_mov_b32_dpp v215, v51 row_ror:1 row_mask:0xf bank_mask:0xf
    v_mfma_f32_16x16x32_bf16 v[160:163], v[192:195], v[56:59], v[160:163]
    v_mov_b32_dpp v212, v52 row_shr:1 row_mask:0xf bank_mask:0xf
    v_mov_b32_dpp v213, v53 row_shr:1 row_mask:0xf bank_mask:0xf
    v_mfma_f32_16x16x32_bf16 v[164:167], v[196:199], v[56:59], v[164:167]
    v_mov_b32_dpp v214, v54 row_shr:1 row_mask:0xf bank_mask:0xf
    v_mov_b32_dpp v215, v55 row_shr:1 row_mask:0xf bank_mask:0xf
    v_mfma_f32_16x16x32_bf16 v[168:171], v[192:195], v[60:63], v[168:171]
    v_mov_b32_dpp v216, v52 row_ror:1 row_mask:0xf bank_mask:0xf
    v_mov_b32_dpp v217, v53 row_ror:1 row_mask:0xf bank_mask:0xf
    v_mfma_f32_16x16x32_bf16 v[172:175], v[196:199], v[60:63], v[172:175]
    v_mov_b32_dpp v218, v54 row_ror:1 row_mask:0xf bank_mask:0xf
    v_mov_b32_dpp v219, v55 row_ror:1 row_mask:0xf bank_mask:0xf
    v_mfma_f32_16x16x32_bf16 v[152:155], v[200:203], v[48:51], v[152:155]
    v_mov_b32_dpp v216, v56 row_shr:1 row_mask:0xf bank_mask:0xf
    v_mov_b32_dpp v217, v57 row_shr:1 row_mask:0xf bank_mask:0xf
    v_mfma_f32_16x16x32_bf16 v[156:159], v[204:207], v[48:51], v[156:159]
    v_mov_b32_dpp v218, v58 row_shr:1 row_mask:0xf bank_mask:0xf
    v_mov_b32_dpp v219, v59 row_shr:1 row_mask:0xf bank_mask:0xf
    v_mfma_f32_16x16x32_bf16 v[160:163], v[200:203], v[52:55], v[160:163]
    v_mov_b32_dpp v220, v56 row_ror:1 row_mask:0xf bank_mask:0xf
    v_mov_b32_dpp v221, v57 row_ror:1 row_mask:0xf bank_mask:0xf
    v_mfma_f32_16x16x32_bf16 v[164:167], v[204:207], v[52:55], v[164:167]
    v_mov_b32_dpp v222, v58 row_ror:1 row_mask:0xf bank_mask:0xf
    v_mov_b32_dpp v223, v59 row_ror:1 row_mask:0xf bank_mask:0xf
    v_mfma_f32_16x16x32_bf16 v[168:171], v[200:203], v[56:59], v[168:171]
    v_mov_b32_dpp v220, v60 row_shr:1 row_mask:0xf bank_mask:0xf
    v_mov_b32_dpp v221, v61 row_shr:1 row_mask:0xf bank_mask:0xf
    v_mfma_f32_16x16x32_bf16 v[172:175], v[204:207], v[56:59], v[172:175]
    v_mov_b32_dpp v222, v62 row_shr:1 row_mask:0xf bank_mask:0xf
    v_mov_b32_dpp v223, v63 row_shr:1 row_mask:0xf bank_mask:0xf
    s_waitcnt lgkmcnt(0)
    ds_read_b64 v[192:193], v8 offset:4224
    ds_read_b64 v[194:195], v8 offset:4256
    ds_read_b64 v[196:197], v8 offset:4096
    ds_read_b64 v[198:199], v8 offset:4128
    ds_read_b64 v[200:201], v8 offset:128
    ds_read_b64 v[202:203], v8 offset:160
    ds_read_b64 v[204:205], v8 offset:0
    ds_read_b64 v[206:207], v8 offset:32
    buffer_load_dwordx2 v[44:45], v2, s[12:15], s71 offen offset:2048
    v_mfma_f32_16x16x32_bf16 v[144:147], v[176:179], v[208:211], v[144:147]
    v_mov_b32_dpp v48, v208 row_shr:1 row_mask:0xf bank_mask:0xf bound_ctrl:0
    v_mov_b32_dpp v49, v209 row_shr:1 row_mask:0xf bank_mask:0xf bound_ctrl:0
    v_mfma_f32_16x16x32_bf16 v[148:151], v[180:183], v[208:211], v[148:151]
    v_mov_b32_dpp v50, v210 row_shr:1 row_mask:0xf bank_mask:0xf bound_ctrl:0
    v_mov_b32_dpp v51, v211 row_shr:1 row_mask:0xf bank_mask:0xf bound_ctrl:0
    v_mfma_f32_16x16x32_bf16 v[152:155], v[176:179], v[212:215], v[152:155]
    v_mov_b32_dpp v52, v208 row_ror:1 row_mask:0xf bank_mask:0xf
    v_mov_b32_dpp v53, v209 row_ror:1 row_mask:0xf bank_mask:0xf
    v_mfma_f32_16x16x32_bf16 v[156:159], v[180:183], v[212:215], v[156:159]
    v_mov_b32_dpp v54, v210 row_ror:1 row_mask:0xf bank_mask:0xf
    v_mov_b32_dpp v55, v211 row_ror:1 row_mask:0xf bank_mask:0xf
    v_mfma_f32_16x16x32_bf16 v[160:163], v[176:179], v[216:219], v[160:163]
    v_mov_b32_dpp v52, v212 row_shr:1 row_mask:0xf bank_mask:0xf
    v_mov_b32_dpp v53, v213 row_shr:1 row_mask:0xf bank_mask:0xf
    v_mfma_f32_16x16x32_bf16 v[164:167], v[180:183], v[216:219], v[164:167]
    v_mov_b32_dpp v54, v214 row_shr:1 row_mask:0xf bank_mask:0xf
    v_mov_b32_dpp v55, v215 row_shr:1 row_mask:0xf bank_mask:0xf
    v_mfma_f32_16x16x32_bf16 v[168:171], v[176:179], v[220:223], v[168:171]
    v_mov_b32_dpp v56, v212 row_ror:1 row_mask:0xf bank_mask:0xf
    v_mov_b32_dpp v57, v213 row_ror:1 row_mask:0xf bank_mask:0xf
    v_mfma_f32_16x16x32_bf16 v[172:175], v[180:183], v[220:223], v[172:175]
    v_mov_b32_dpp v58, v214 row_ror:1 row_mask:0xf bank_mask:0xf
    v_mov_b32_dpp v59, v215 row_ror:1 row_mask:0xf bank_mask:0xf
    v_mfma_f32_16x16x32_bf16 v[152:155], v[184:187], v[208:211], v[152:155]
    v_mov_b32_dpp v56, v216 row_shr:1 row_mask:0xf bank_mask:0xf
    v_mov_b32_dpp v57, v217 row_shr:1 row_mask:0xf bank_mask:0xf
    v_mfma_f32_16x16x32_bf16 v[156:159], v[188:191], v[208:211], v[156:159]
    v_mov_b32_dpp v58, v218 row_shr:1 row_mask:0xf bank_mask:0xf
    v_mov_b32_dpp v59, v219 row_shr:1 row_mask:0xf bank_mask:0xf
    v_mfma_f32_16x16x32_bf16 v[160:163], v[184:187], v[212:215], v[160:163]
    v_mov_b32_dpp v60, v216 row_ror:1 row_mask:0xf bank_mask:0xf
    v_mov_b32_dpp v61, v217 row_ror:1 row_mask:0xf bank_mask:0xf
    v_mfma_f32_16x16x32_bf16 v[164:167], v[188:191], v[212:215], v[164:167]
    v_mov_b32_dpp v62, v218 row_ror:1 row_mask:0xf bank_mask:0xf
    v_mov_b32_dpp v63, v219 row_ror:1 row_mask:0xf bank_mask:0xf
    v_mfma_f32_16x16x32_bf16 v[168:171], v[184:187], v[216:219], v[168:171]
    v_mov_b32_dpp v60, v220 row_shr:1 row_mask:0xf bank_mask:0xf
    v_mov_b32_dpp v61, v221 row_shr:1 row_mask:0xf bank_mask:0xf
    v_mfma_f32_16x16x32_bf16 v[172:175], v[188:191], v[216:219], v[172:175]
    v_mov_b32_dpp v62, v222 row_shr:1 row_mask:0xf bank_mask:0xf
    v_mov_b32_dpp v63, v223 row_shr:1 row_mask:0xf bank_mask:0xf
    v_subrev_u32 v8, 512, v8
    s_waitcnt lgkmcnt(0)
    ds_read_b64 v[176:177], v8 offset:4480
    ds_read_b64 v[178:179], v8 offset:4512
    ds_read_b64 v[180:181], v8 offset:4352
    ds_read_b64 v[182:183], v8 offset:4384
    ds_read_b64 v[184:185], v8 offset:384
    ds_read_b64 v[186:187], v8 offset:416
    ds_read_b64 v[188:189], v8 offset:256
    ds_read_b64 v[190:191], v8 offset:288
    v_mfma_f32_16x16x32_bf16 v[144:147], v[192:195], v[48:51], v[144:147]
    v_mov_b32_dpp v208, v48 row_shr:1 row_mask:0xf bank_mask:0xf bound_ctrl:0
    v_mov_b32_dpp v209, v49 row_shr:1 row_mask:0xf bank_mask:0xf bound_ctrl:0
    v_mfma_f32_16x16x32_bf16 v[148:151], v[196:199], v[48:51], v[148:151]
    v_mov_b32_dpp v210, v50 row_shr:1 row_mask:0xf bank_mask:0xf bound_ctrl:0
    v_mov_b32_dpp v211, v51 row_shr:1 row_mask:0xf bank_mask:0xf bound_ctrl:0
    v_mfma_f32_16x16x32_bf16 v[152:155], v[192:195], v[52:55], v[152:155]
    v_mov_b32_dpp v212, v48 row_ror:1 row_mask:0xf bank_mask:0xf
    v_mov_b32_dpp v213, v49 row_ror:1 row_mask:0xf bank_mask:0xf
    v_mfma_f32_16x16x32_bf16 v[156:159], v[196:199], v[52:55], v[156:159]
    v_mov_b32_dpp v214, v50 row_ror:1 row_mask:0xf bank_mask:0xf
    v_mov_b32_dpp v215, v51 row_ror:1 row_mask:0xf bank_mask:0xf
    v_mfma_f32_16x16x32_bf16 v[160:163], v[192:195], v[56:59], v[160:163]
    v_mov_b32_dpp v212, v52 row_shr:1 row_mask:0xf bank_mask:0xf
    v_mov_b32_dpp v213, v53 row_shr:1 row_mask:0xf bank_mask:0xf
    v_mfma_f32_16x16x32_bf16 v[164:167], v[196:199], v[56:59], v[164:167]
    v_mov_b32_dpp v214, v54 row_shr:1 row_mask:0xf bank_mask:0xf
    v_mov_b32_dpp v215, v55 row_shr:1 row_mask:0xf bank_mask:0xf
    v_mfma_f32_16x16x32_bf16 v[168:171], v[192:195], v[60:63], v[168:171]
    v_mov_b32_dpp v216, v52 row_ror:1 row_mask:0xf bank_mask:0xf
    v_mov_b32_dpp v217, v53 row_ror:1 row_mask:0xf bank_mask:0xf
    v_mfma_f32_16x16x32_bf16 v[172:175], v[196:199], v[60:63], v[172:175]
    v_mov_b32_dpp v218, v54 row_ror:1 row_mask:0xf bank_mask:0xf
    v_mov_b32_dpp v219, v55 row_ror:1 row_mask:0xf bank_mask:0xf
    v_mfma_f32_16x16x32_bf16 v[152:155], v[200:203], v[48:51], v[152:155]
    v_mov_b32_dpp v216, v56 row_shr:1 row_mask:0xf bank_mask:0xf
    v_mov_b32_dpp v217, v57 row_shr:1 row_mask:0xf bank_mask:0xf
    v_mfma_f32_16x16x32_bf16 v[156:159], v[204:207], v[48:51], v[156:159]
    v_mov_b32_dpp v218, v58 row_shr:1 row_mask:0xf bank_mask:0xf
    v_mov_b32_dpp v219, v59 row_shr:1 row_mask:0xf bank_mask:0xf
    v_mfma_f32_16x16x32_bf16 v[160:163], v[200:203], v[52:55], v[160:163]
    v_mov_b32_dpp v220, v56 row_ror:1 row_mask:0xf bank_mask:0xf
    v_mov_b32_dpp v221, v57 row_ror:1 row_mask:0xf bank_mask:0xf
    v_mfma_f32_16x16x32_bf16 v[164:167], v[204:207], v[52:55], v[164:167]
    v_mov_b32_dpp v222, v58 row_ror:1 row_mask:0xf bank_mask:0xf
    v_mov_b32_dpp v223, v59 row_ror:1 row_mask:0xf bank_mask:0xf
    v_mfma_f32_16x16x32_bf16 v[168:171], v[200:203], v[56:59], v[168:171]
    v_mov_b32_dpp v220, v60 row_shr:1 row_mask:0xf bank_mask:0xf
    v_mov_b32_dpp v221, v61 row_shr:1 row_mask:0xf bank_mask:0xf
    v_mfma_f32_16x16x32_bf16 v[172:175], v[204:207], v[56:59], v[172:175]
    v_mov_b32_dpp v222, v62 row_shr:1 row_mask:0xf bank_mask:0xf
    v_mov_b32_dpp v223, v63 row_shr:1 row_mask:0xf bank_mask:0xf
    s_waitcnt lgkmcnt(0)
    v_add_u32 v133, 2048, v138
    v_mov_b32 v134, v139
    v_mov_b32 v135, v1
    s_mov_b32 s96, 5
Lcp_15:
    ds_read_b64 v[120:121], v133
    ds_read_b64 v[122:123], v133 offset:8
    v_cmp_gt_u32 vcc, 263, v135
    v_subrev_u32 v133, 512, v133
    v_add_u32 v135, 64, v135
    s_waitcnt lgkmcnt(0)
    v_alignbit_b32 v240, v123, v123, 16
    v_alignbit_b32 v241, v122, v122, 16
    v_bfi_b32 v242, v140, v123, v122
    v_bfi_b32 v243, v140, v122, v121
    v_mov_b32 v244, v241
    v_alignbit_b32 v245, v121, v121, 16
    v_mov_b32 v246, v243
    v_bfi_b32 v247, v140, v121, v120
    s_and_saveexec_b64 s[42:43], vcc
    ds_write_b128 v134, v[240:243]
    ds_write_b128 v134, v[244:247] offset:16
    s_mov_b64 exec, s[42:43]
    v_add_u32 v134, 2048, v134
    s_sub_u32 s96, s96, 1
    s_cmp_lg_u32 s96, 0
    s_cbranch_scc1 Lcp_15
    s_waitcnt lgkmcnt(0)
    v_mov_b32 v8, v130
    ds_read_b64 v[176:177], v8 offset:4480
    ds_read_b64 v[178:179], v8 offset:4512
    ds_read_b64 v[180:181], v8 offset:4352
    ds_read_b64 v[182:183], v8 offset:4384
    ds_read_b64 v[184:185], v8 offset:384
    ds_read_b64 v[186:187], v8 offset:416
    ds_read_b64 v[188:189], v8 offset:256
    ds_read_b64 v[190:191], v8 offset:288
    ds_read_b128 v[208:211], v132 offset:0
    ds_read_b128 v[212:215], v132 offset:1024
    s_mov_b32 s96, 8
Lcv_16:
    s_waitcnt lgkmcnt(0)
    ds_read_b64 v[192:193], v8 offset:4224
    ds_read_b64 v[194:195], v8 offset:4256
    ds_read_b64 v[196:197], v8 offset:4096
    ds_read_b64 v[198:199], v8 offset:4128
    ds_read_b64 v[200:201], v8 offset:128
    ds_read_b64 v[202:203], v8 offset:160
    ds_read_b64 v[204:205], v8 offset:0
    ds_read_b64 v[206:207], v8 offset:32
    v_mfma_f32_16x16x32_bf16 v[160:163], v[176:179], v[208:211], v[160:163]
    v_mov_b32_dpp v48, v208 row_shr:1 row_mask:0xf bank_mask:0xf bound_ctrl:0
    v_mov_b32_dpp v49, v209 row_shr:1 row_mask:0xf bank_mask:0xf bound_ctrl:0
    v_mfma_f32_16x16x32_bf16 v[164:167], v[180:183], v[208:211], v[164:167]
    v_mov_b32_dpp v50, v210 row_shr:1 row_mask:0xf bank_mask:0xf bound_ctrl:0
    v_mov_b32_dpp v51, v211 row_shr:1 row_mask:0xf bank_mask:0xf bound_ctrl:0
    v_mfma_f32_16x16x32_bf16 v[168:171], v[176:179], v[212:215], v[168:171]
    v_mov_b32_dpp v52, v208 row_ror:1 row_mask:0xf bank_mask:0xf
    v_mov_b32_dpp v53, v209 row_ror:1 row_mask:0xf bank_mask:0xf
    v_mfma_f32_16x16x32_bf16 v[172:175], v[180:183], v[212:215], v[172:175]
    v_mov_b32_dpp v54, v210 row_ror:1 row_mask:0xf bank_mask:0xf
    v_mov_b32_dpp v55, v211 row_ror:1 row_mask:0xf bank_mask:0xf
    v_mfma_f32_16x16x32_bf16 v[168:171], v[184:187], v[208:211], v[168:171]
    v_mov_b32_dpp v52, v212 row_shr:1 row_mask:0xf bank_mask:0xf
    v_mov_b32_dpp v53, v213 row_shr:1 row_mask:0xf bank_mask:0xf
    v_mfma_f32_16x16x32_bf16 v[172:175], v[188:191], v[208:211], v[172:175]
    v_mov_b32_dpp v54, v214 row_shr:1 row_mask:0xf bank_mask:0xf
    v_mov_b32_dpp v55, v215 row_shr:1 row_mask:0xf bank_mask:0xf
    v_subrev_u32 v8, 512, v8
    s_waitcnt lgkmcnt(0)
    ds_read_b64 v[176:177], v8 offset:4480
    ds_read_b64 v[178:179], v8 offset:4512
    ds_read_b64 v[180:181], v8 offset:4352
    ds_read_b64 v[182:183], v8 offset:4384
    ds_read_b64 v[184:185], v8 offset:384
    ds_read_b64 v[186:187], v8 offset:416
    ds_read_b64 v[188:189], v8 offset:256
    ds_read_b64 v[190:191], v8 offset:288
    v_mfma_f32_16x16x32_bf16 v[160:163], v[192:195], v[48:51], v[160:163]
    v_mov_b32_dpp v208, v48 row_shr:1 row_mask:0xf bank_mask:0xf bound_ctrl:0
    v_mov_b32_dpp v209, v49 row_shr:1 row_mask:0xf bank_mask:0xf bound_ctrl:0
    v_mfma_f32_16x16x32_bf16 v[164:167], v[196:199], v[48:51], v[164:167]
    v_mov_b32_dpp v210, v50 row_shr:1 row_mask:0xf bank_mask:0xf bound_ctrl:0
    v_mov_b32_dpp v211, v51 row_shr:1 row_mask:0xf bank_mask:0xf bound_ctrl:0
    v_mfma_f32_16x16x32_bf16 v[168:171], v[192:195], v[52:55], v[168:171]
    v_mov_b32_dpp v212, v48 row_ror:1 row_mask:0xf bank_mask:0xf
    v_mov_b32_dpp v213, v49 row_ror:1 row_mask:0xf bank_mask:0xf
    v_mfma_f32_16x16x32_bf16 v[172:175], v[196:199], v[52:55], v[172:175]
    v_mov_b32_dpp v214, v50 row_ror:1 row_mask:0xf bank_mask:0xf
    v_mov_b32_dpp v215, v51 row_ror:1 row_mask:0xf bank_mask:0xf
    v_mfma_f32_16x16x32_bf16 v[168:171], v[200:203], v[48:51], v[168:171]
    v_mov_b32_dpp v212, v52 row_shr:1 row_mask:0xf bank_mask:0xf
    v_mov_b32_dpp v213, v53 row_shr:1 row_mask:0xf bank_mask:0xf
    v_mfma_f32_16x16x32_bf16 v[172:175], v[204:207], v[48:51], v[172:175]
    v_mov_b32_dpp v214, v54 row_shr:1 row_mask:0xf bank_mask:0xf
    v_mov_b32_dpp v215, v55 row_shr:1 row_mask:0xf bank_mask:0xf
    s_sub_u32 s96, s96, 1
    s_cmp_lg_u32 s96, 0
    s_cbranch_scc1 Lcv_16
    s_waitcnt lgkmcnt(0)
    ds_read_b64 v[176:177], v9 offset:0
    ds_read_b64 v[178:179], v9 offset:32
    ds_read_b64 v[180:181], v9 offset:1024
    ds_read_b64 v[182:183], v9 offset:1056
    ds_read_b64 v[184:185], v9 offset:2048
    ds_read_b64 v[186:187], v9 offset:2080
    ds_read_b64 v[188:189], v9 offset:3072
    ds_read_b64 v[190:191], v9 offset:3104
    s_waitcnt lgkmcnt(0)
    v_cvt_pk_bf16_f32 v48, v144, v145
    v_cvt_pk_bf16_f32 v56, v146, v147
    v_cvt_pk_bf16_f32 v64, v148, v149
    v_cvt_pk_bf16_f32 v72, v150, v151
    v_lshlrev_b32 v50, 16, v176
    v_lshlrev_b32 v58, 16, v177
    v_lshlrev_b32 v66, 16, v178
    v_lshlrev_b32 v74, 16, v179
    v_and_b32 v51, 0xffff0000, v176
    v_and_b32 v59, 0xffff0000, v177
    v_and_b32 v67, 0xffff0000, v178
    v_and_b32 v75, 0xffff0000, v179
    v_mul_f32 v50, s85, v50
    v_mul_f32 v58, s85, v58
    v_mul_f32 v66, s85, v66
    v_mul_f32 v74, s85, v74
    v_mul_f32 v51, s85, v51
    v_mul_f32 v59, s85, v59
    v_mul_f32 v67, s85, v67
    v_mul_f32 v75, s85, v75
    v_cvt_pk_bf16_f32 v49, v50, v51
    v_cvt_pk_bf16_f32 v57, v58, v59
    v_cvt_pk_bf16_f32 v65, v66, v67
    v_cvt_pk_bf16_f32 v73, v74, v75
    v_lshlrev_b32 v50, 16, v48
    v_lshlrev_b32 v58, 16, v56
    v_lshlrev_b32 v66, 16, v64
    v_lshlrev_b32 v74, 16, v72
    v_and_b32 v51, 0xffff0000, v48
    v_and_b32 v59, 0xffff0000, v56
    v_and_b32 v67, 0xffff0000, v64
    v_and_b32 v75, 0xffff0000, v72
    v_lshlrev_b32 v52, 16, v49
    v_lshlrev_b32 v60, 16, v57
    v_lshlrev_b32 v68, 16, v65
    v_lshlrev_b32 v76, 16, v73
    v_and_b32 v53, 0xffff0000, v49
    v_and_b32 v61, 0xffff0000, v57
    v_and_b32 v69, 0xffff0000, v65
    v_and_b32 v77, 0xffff0000, v73
    v_pk_add_f32 v[50:51], v[50:51], v[52:53]
    v_pk_add_f32 v[58:59], v[58:59], v[60:61]
    v_pk_add_f32 v[66:67], v[66:67], v[68:69]
    v_pk_add_f32 v[74:75], v[74:75], v[76:77]
    v_cvt_pk_bf16_f32 v120, v50, v51
    v_cvt_pk_bf16_f32 v121, v58, v59
    v_cvt_pk_bf16_f32 v122, v66, v67
    v_cvt_pk_bf16_f32 v123, v74, v75
    ds_write_b64 v9, v[120:121] offset:0
    ds_write_b64 v9, v[122:123] offset:32
    v_cvt_pk_bf16_f32 v48, v152, v153
    v_cvt_pk_bf16_f32 v56, v154, v155
    v_cvt_pk_bf16_f32 v64, v156, v157
    v_cvt_pk_bf16_f32 v72, v158, v159
    v_lshlrev_b32 v50, 16, v180
    v_lshlrev_b32 v58, 16, v181
    v_lshlrev_b32 v66, 16, v182
    v_lshlrev_b32 v74, 16, v183
    v_and_b32 v51, 0xffff0000, v180
    v_and_b32 v59, 0xffff0000, v181
    v_and_b32 v67, 0xffff0000, v182
    v_and_b32 v75, 0xffff0000, v183
    v_mul_f32 v50, s85, v50
    v_mul_f32 v58, s85, v58
    v_mul_f32 v66, s85, v66
    v_mul_f32 v74, s85, v74
    v_mul_f32 v51, s85, v51
    v_mul_f32 v59, s85, v59
    v_mul_f32 v67, s85, v67
    v_mul_f32 v75, s85, v75
    v_cvt_pk_bf16_f32 v49, v50, v51
    v_cvt_pk_bf16_f32 v57, v58, v59
    v_cvt_pk_bf16_f32 v65, v66, v67
    v_cvt_pk_bf16_f32 v73, v74, v75
    v_lshlrev_b32 v50, 16, v48
    v_lshlrev_b32 v58, 16, v56
    v_lshlrev_b32 v66, 16, v64
    v_lshlrev_b32 v74, 16, v72
    v_and_b32 v51, 0xffff0000, v48
    v_and_b32 v59, 0xffff0000, v56
    v_and_b32 v67, 0xffff0000, v64
    v_and_b32 v75, 0xffff0000, v72
    v_lshlrev_b32 v52, 16, v49
    v_lshlrev_b32 v60, 16, v57
    v_lshlrev_b32 v68, 16, v65
    v_lshlrev_b32 v76, 16, v73
    v_and_b32 v53, 0xffff0000, v49
    v_and_b32 v61, 0xffff0000, v57
    v_and_b32 v69, 0xffff0000, v65
    v_and_b32 v77, 0xffff0000, v73
    v_pk_add_f32 v[50:51], v[50:51], v[52:53]
    v_pk_add_f32 v[58:59], v[58:59], v[60:61]
    v_pk_add_f32 v[66:67], v[66:67], v[68:69]
    v_pk_add_f32 v[74:75], v[74:75], v[76:77]
    v_cvt_pk_bf16_f32 v120, v50, v51
    v_cvt_pk_bf16_f32 v121, v58, v59
    v_cvt_pk_bf16_f32 v122, v66, v67
    v_cvt_pk_bf16_f32 v123, v74, v75
    ds_write_b64 v9, v[120:121] offset:1024
    ds_write_b64 v9, v[122:123] offset:1056
    v_cvt_pk_bf16_f32 v48, v160, v161
    v_cvt_pk_bf16_f32 v56, v162, v163
    v_cvt_pk_bf16_f32 v64, v164, v165
    v_cvt_pk_bf16_f32 v72, v166, v167
    v_lshlrev_b32 v50, 16, v184
    v_lshlrev_b32 v58, 16, v185
    v_lshlrev_b32 v66, 16, v186
    v_lshlrev_b32 v74, 16, v187
    v_and_b32 v51, 0xffff0000, v184
    v_and_b32 v59, 0xffff0000, v185
    v_and_b32 v67, 0xffff0000, v186
    v_and_b32 v75, 0xffff0000, v187
    v_mul_f32 v50, s85, v50
    v_mul_f32 v58, s85, v58
    v_mul_f32 v66, s85, v66
    v_mul_f32 v74, s85, v74
    v_mul_f32 v51, s85, v51
    v_mul_f32 v59, s85, v59
    v_mul_f32 v67, s85, v67
    v_mul_f32 v75, s85, v75
    v_cvt_pk_bf16_f32 v49, v50, v51
    v_cvt_pk_bf16_f32 v57, v58, v59
    v_cvt_pk_bf16_f32 v65, v66, v67
    v_cvt_pk_bf16_f32 v73, v74, v75
    v_lshlrev_b32 v50, 16, v48
    v_lshlrev_b32 v58, 16, v56
    v_lshlrev_b32 v66, 16, v64
    v_lshlrev_b32 v74, 16, v72
    v_and_b32 v51, 0xffff0000, v48
    v_and_b32 v59, 0xffff0000, v56
    v_and_b32 v67, 0xffff0000, v64
    v_and_b32 v75, 0xffff0000, v72
    v_lshlrev_b32 v52, 16, v49
    v_lshlrev_b32 v60, 16, v57
    v_lshlrev_b32 v68, 16, v65
    v_lshlrev_b32 v76, 16, v73
    v_and_b32 v53, 0xffff0000, v49
    v_and_b32 v61, 0xffff0000, v57
    v_and_b32 v69, 0xffff0000, v65
    v_and_b32 v77, 0xffff0000, v73
    v_pk_add_f32 v[50:51], v[50:51], v[52:53]
    v_pk_add_f32 v[58:59], v[58:59], v[60:61]
    v_pk_add_f32 v[66:67], v[66:67], v[68:69]
    v_pk_add_f32 v[74:75], v[74:75], v[76:77]
    v_cvt_pk_bf16_f32 v120, v50, v51
    v_cvt_pk_bf16_f32 v121, v58, v59
    v_cvt_pk_bf16_f32 v122, v66, v67
    v_cvt_pk_bf16_f32 v123, v74, v75
    ds_write_b64 v9, v[120:121] offset:2048
    ds_write_b64 v9, v[122:123] offset:2080
    v_cvt_pk_bf16_f32 v48, v168, v169
    v_cvt_pk_bf16_f32 v56, v170, v171
    v_cvt_pk_bf16_f32 v64, v172, v173
    v_cvt_pk_bf16_f32 v72, v174, v175
    v_lshlrev_b32 v50, 16, v188
    v_lshlrev_b32 v58, 16, v189
    v_lshlrev_b32 v66, 16, v190
    v_lshlrev_b32 v74, 16, v191
    v_and_b32 v51, 0xffff0000, v188
    v_and_b32 v59, 0xffff0000, v189
    v_and_b32 v67, 0xffff0000, v190
    v_and_b32 v75, 0xffff0000, v191
    v_mul_f32 v50, s85, v50
    v_mul_f32 v58, s85, v58
    v_mul_f32 v66, s85, v66
    v_mul_f32 v74, s85, v74
    v_mul_f32 v51, s85, v51
    v_mul_f32 v59, s85, v59
    v_mul_f32 v67, s85, v67
    v_mul_f32 v75, s85, v75
    v_cvt_pk_bf16_f32 v49, v50, v51
    v_cvt_pk_bf16_f32 v57, v58, v59
    v_cvt_pk_bf16_f32 v65, v66, v67
    v_cvt_pk_bf16_f32 v73, v74, v75
    v_lshlrev_b32 v50, 16, v48
    v_lshlrev_b32 v58, 16, v56
    v_lshlrev_b32 v66, 16, v64
    v_lshlrev_b32 v74, 16, v72
    v_and_b32 v51, 0xffff0000, v48
    v_and_b32 v59, 0xffff0000, v56
    v_and_b32 v67, 0xffff0000, v64
    v_and_b32 v75, 0xffff0000, v72
    v_lshlrev_b32 v52, 16, v49
    v_lshlrev_b32 v60, 16, v57
    v_lshlrev_b32 v68, 16, v65
    v_lshlrev_b32 v76, 16, v73
    v_and_b32 v53, 0xffff0000, v49
    v_and_b32 v61, 0xffff0000, v57
    v_and_b32 v69, 0xffff0000, v65
    v_and_b32 v77, 0xffff0000, v73
    v_pk_add_f32 v[50:51], v[50:51], v[52:53]
    v_pk_add_f32 v[58:59], v[58:59], v[60:61]
    v_pk_add_f32 v[66:67], v[66:67], v[68:69]
    v_pk_add_f32 v[74:75], v[74:75], v[76:77]
    v_cvt_pk_bf16_f32 v120, v50, v51
    v_cvt_pk_bf16_f32 v121, v58, v59
    v_cvt_pk_bf16_f32 v122, v66, v67
    v_cvt_pk_bf16_f32 v123, v74, v75
    ds_write_b64 v9, v[120:121] offset:3072
    ds_write_b64 v9, v[122:123] offset:3104
    s_waitcnt lgkmcnt(0)
    v_mov_b32 v120, 20836
    v_mov_b32 v121, 1
    v_cmp_eq_u32 vcc, 0, v1
    s_nop 0
    s_and_saveexec_b64 s[42:43], vcc
    ds_add_u32 v120, v121
    s_mov_b64 exec, s[42:43]
    s_nop 0
Lsp_17:
    ds_read_b32 v121, v120
    s_waitcnt lgkmcnt(0)
    v_readfirstlane_b32 s96, v121
    s_nop 0
    s_cmp_lt_u32 s96, 4
    s_nop 2
    s_cbranch_scc1 Lsp_17
    ds_read_b128 v[48:51], v7 offset:0
    ds_read_b128 v[52:55], v7 offset:40960
    ds_read_b128 v[56:59], v141 offset:0
    ds_read_b128 v[60:63], v141 offset:40960
    s_waitcnt vmcnt(0) lgkmcnt(0)
    v_perm_b32 v120, v52, v48, s100
    v_perm_b32 v126, v60, v56, s100
    v_lshlrev_b32 v122, 16, v120
    v_lshlrev_b32 v128, 16, v126
    v_and_b32 v123, 0xffff0000, v120
    v_and_b32 v129, 0xffff0000, v126
    v_lshlrev_b32 v124, 16, v30
    v_lshlrev_b32 v130, 16, v31
    v_and_b32 v125, 0xffff0000, v30
    v_and_b32 v131, 0xffff0000, v31
    v_pk_mul_f32 v[122:123], v[122:123], v[124:125]
    v_pk_mul_f32 v[128:129], v[128:129], v[130:131]
    v_cvt_pk_bf16_f32 v70, v122, v123
    v_cvt_pk_bf16_f32 v71, v128, v129
    buffer_store_dwordx2 v[70:71], v3, s[28:31], s68 offen
    v_perm_b32 v120, v52, v48, s101
    v_perm_b32 v126, v60, v56, s101
    v_lshlrev_b32 v122, 16, v120
    v_lshlrev_b32 v128, 16, v126
    v_and_b32 v123, 0xffff0000, v120
    v_and_b32 v129, 0xffff0000, v126
    v_lshlrev_b32 v124, 16, v32
    v_lshlrev_b32 v130, 16, v33
    v_and_b32 v125, 0xffff0000, v32
    v_and_b32 v131, 0xffff0000, v33
    v_pk_mul_f32 v[122:123], v[122:123], v[124:125]
    v_pk_mul_f32 v[128:129], v[128:129], v[130:131]
    v_cvt_pk_bf16_f32 v72, v122, v123
    v_cvt_pk_bf16_f32 v73, v128, v129
    buffer_store_dwordx2 v[72:73], v3, s[28:31], s69 offen
    v_perm_b32 v120, v53, v49, s100
    v_perm_b32 v126, v61, v57, s100
    v_lshlrev_b32 v122, 16, v120
    v_lshlrev_b32 v128, 16, v126
    v_and_b32 v123, 0xffff0000, v120
    v_and_b32 v129, 0xffff0000, v126
    v_lshlrev_b32 v124, 16, v34
    v_lshlrev_b32 v130, 16, v35
    v_and_b32 v125, 0xffff0000, v34
    v_and_b32 v131, 0xffff0000, v35
    v_pk_mul_f32 v[122:123], v[122:123], v[124:125]
    v_pk_mul_f32 v[128:129], v[128:129], v[130:131]
    v_cvt_pk_bf16_f32 v74, v122, v123
    v_cvt_pk_bf16_f32 v75, v128, v129
    buffer_store_dwordx2 v[74:75], v3, s[28:31], s70 offen
    v_perm_b32 v120, v53, v49, s101
    v_perm_b32 v126, v61, v57, s101
    v_lshlrev_b32 v122, 16, v120
    v_lshlrev_b32 v128, 16, v126
    v_and_b32 v123, 0xffff0000, v120
    v_and_b32 v129, 0xffff0000, v126
    v_lshlrev_b32 v124, 16, v36
    v_lshlrev_b32 v130, 16, v37
    v_and_b32 v125, 0xffff0000, v36
    v_and_b32 v131, 0xffff0000, v37
    v_pk_mul_f32 v[122:123], v[122:123], v[124:125]
    v_pk_mul_f32 v[128:129], v[128:129], v[130:131]
    v_cvt_pk_bf16_f32 v76, v122, v123
    v_cvt_pk_bf16_f32 v77, v128, v129
    buffer_store_dwordx2 v[76:77], v3, s[28:31], s71 offen
    v_perm_b32 v120, v54, v50, s100
    v_perm_b32 v126, v62, v58, s100
    v_lshlrev_b32 v122, 16, v120
    v_lshlrev_b32 v128, 16, v126
    v_and_b32 v123, 0xffff0000, v120
    v_and_b32 v129, 0xffff0000, v126
    v_lshlrev_b32 v124, 16, v38
    v_lshlrev_b32 v130, 16, v39
    v_and_b32 v125, 0xffff0000, v38
    v_and_b32 v131, 0xffff0000, v39
    v_pk_mul_f32 v[122:123], v[122:123], v[124:125]
    v_pk_mul_f32 v[128:129], v[128:129], v[130:131]
    v_cvt_pk_bf16_f32 v70, v122, v123
    v_cvt_pk_bf16_f32 v71, v128, v129
    buffer_store_dwordx2 v[70:71], v3, s[28:31], s72 offen
    v_perm_b32 v120, v54, v50, s101
    v_perm_b32 v126, v62, v58, s101
    v_lshlrev_b32 v122, 16, v120
    v_lshlrev_b32 v128, 16, v126
    v_and_b32 v123, 0xffff0000, v120
    v_and_b32 v129, 0xffff0000, v126
    v_lshlrev_b32 v124, 16, v40
    v_lshlrev_b32 v130, 16, v41
    v_and_b32 v125, 0xffff0000, v40
    v_and_b32 v131, 0xffff0000, v41
    v_pk_mul_f32 v[122:123], v[122:123], v[124:125]
    v_pk_mul_f32 v[128:129], v[128:129], v[130:131]
    v_cvt_pk_bf16_f32 v72, v122, v123
    v_cvt_pk_bf16_f32 v73, v128, v129
    buffer_store_dwordx2 v[72:73], v3, s[28:31], s73 offen
    v_perm_b32 v120, v55, v51, s100
    v_perm_b32 v126, v63, v59, s100
    v_lshlrev_b32 v122, 16, v120
    v_lshlrev_b32 v128, 16, v126
    v_and_b32 v123, 0xffff0000, v120
    v_and_b32 v129, 0xffff0000, v126
    v_lshlrev_b32 v124, 16, v42
    v_lshlrev_b32 v130, 16, v43
    v_and_b32 v125, 0xffff0000, v42
    v_and_b32 v131, 0xffff0000, v43
    v_pk_mul_f32 v[122:123], v[122:123], v[124:125]
    v_pk_mul_f32 v[128:129], v[128:129], v[130:131]
    v_cvt_pk_bf16_f32 v74, v122, v123
    v_cvt_pk_bf16_f32 v75, v128, v129
    buffer_store_dwordx2 v[74:75], v3, s[28:31], s74 offen
    v_perm_b32 v120, v55, v51, s101
    v_perm_b32 v126, v63, v59, s101
    v_lshlrev_b32 v122, 16, v120
    v_lshlrev_b32 v128, 16, v126
    v_and_b32 v123, 0xffff0000, v120
    v_and_b32 v129, 0xffff0000, v126
    v_lshlrev_b32 v124, 16, v44
    v_lshlrev_b32 v130, 16, v45
    v_and_b32 v125, 0xffff0000, v44
    v_and_b32 v131, 0xffff0000, v45
    v_pk_mul_f32 v[122:123], v[122:123], v[124:125]
    v_pk_mul_f32 v[128:129], v[128:129], v[130:131]
    v_cvt_pk_bf16_f32 v76, v122, v123
    v_cvt_pk_bf16_f32 v77, v128, v129
    buffer_store_dwordx2 v[76:77], v3, s[28:31], s75 offen
    s_nop 3
L_done:
L_end:
    s_endpgm
.section .rodata,"a"
.p2align 6
.amdhsa_kernel concat_heads__ssm_conv_s4d__ssm_conv_h3__prompt_kernel
  .amdhsa_next_free_vgpr 248
  .amdhsa_next_free_sgpr 102
  .amdhsa_accum_offset 248
  .amdhsa_group_segment_fixed_size 0
  .amdhsa_kernarg_size 128
  .amdhsa_user_sgpr_count 2
  .amdhsa_user_sgpr_kernarg_segment_ptr 1
  .amdhsa_system_sgpr_workgroup_id_x 1
.end_amdhsa_kernel
```
